```python
import torch

def _softmax(x, axis=-1):
    return torch.softmax(x, dim=axis)

def _gelu(x):
    return torch.nn.functional.gelu(x, approximate='tanh')

def _silu(x):
    return torch.nn.functional.silu(x)

def _sigmoid(x):
    return torch.sigmoid(x)

def _layernorm(x, axis=-1, eps=1e-05):
    m = x.mean(dim=axis, keepdim=True)
    v = x.var(dim=axis, keepdim=True, unbiased=False)
    return (x - m) / torch.sqrt(v + eps)

def _scatter_add(tgt, idx, src, axis=0):
    return tgt.clone().index_add_(axis, idx, src)

def _segment_sum(src, seg, n):
    out = torch.zeros((n,) + src.shape[1:], dtype=src.dtype)
    return out.index_add_(0, seg, src)

def _pad(x, pw):
    flat = tuple((v for pair in reversed(pw) for v in pair))
    return torch.nn.functional.pad(x, flat)
kernel_name = 'standalone__tree_speculative_verify_tree_attention_over_candidate_token_tree__sampling'

def setup_inputs():

    _w = lambda a: (lambda t: t.to(torch.bfloat16) if t.is_floating_point() else t)(torch.as_tensor(a))
    B, Hq, Hkv, T, C, D = (32, 32, 4, 32, 2048, 128)
    tree_mask = torch.zeros((B, T, T), dtype=float)
    for b in range(B):
        parent = torch.zeros(T, dtype=torch.int64)
        for i in range(1, T):
            parent[i] = int(torch.randint(0, i, (1,)).item())
        for i in range(T):
            j = i
            tree_mask[b, i, j] = 1.0
            while j > 0:
                j = parent[j]
                tree_mask[b, i, j] = 1.0
    return {'q': _w((lambda *s: torch.randn(*s, dtype=torch.bfloat16) * 0.8)(B, Hq, T, D)), 'k_cache': _w((lambda *s: torch.randn(*s, dtype=torch.bfloat16) * 0.8)(B, Hkv, C, D)), 'v_cache': _w((lambda *s: torch.randn(*s, dtype=torch.bfloat16) * 0.05)(B, Hkv, C, D)), 'k_tree': _w((lambda *s: torch.randn(*s, dtype=torch.bfloat16) * 0.8)(B, Hkv, T, D)), 'v_tree': _w((lambda *s: torch.randn(*s, dtype=torch.bfloat16) * 0.05)(B, Hkv, T, D)), 'tree_mask': _w(tree_mask)}

def reference(q, k_cache, v_cache, k_tree, v_tree, tree_mask):
    B, Hq, T, D = q.shape
    Hkv, C = (k_cache.shape[1], k_cache.shape[2])
    rep = Hq // Hkv
    kc = (lambda x, n, axis: torch.repeat_interleave(x, n, dim=axis))(k_cache, rep, axis=1)
    vc = (lambda x, n, axis: torch.repeat_interleave(x, n, dim=axis))(v_cache, rep, axis=1)
    kt = (lambda x, n, axis: torch.repeat_interleave(x, n, dim=axis))(k_tree, rep, axis=1)
    vt = (lambda x, n, axis: torch.repeat_interleave(x, n, dim=axis))(v_tree, rep, axis=1)
    k = torch.concatenate([kc, kt], axis=2)
    v = torch.concatenate([vc, vt], axis=2)
    scale = D ** (-0.5)
    scores = torch.einsum('bhqd,bhkd->bhqk', q, k) * scale
    ctx_mask = torch.ones((B, 1, T, C), dtype=scores.dtype)
    tm = tree_mask[:, None, :, :].clone()
    full_mask = torch.concatenate([ctx_mask, tm], axis=-1)
    scores = scores + (1.0 - full_mask) * -1000000000.0
    p = _softmax(scores, axis=-1)
    return torch.einsum('bhqk,bhkd->bhqd', p, v)
```

```asm
; @launch grid=(256,1,1) block=(256,1,1) lds=163840
.amdgcn_target "amdgcn-amd-amdhsa--gfx950"
.text
.globl standalone__tree_speculative_verify_tree_attention_over_candidate_token_tree__sampling_kernel
.p2align 8
.type standalone__tree_speculative_verify_tree_attention_over_candidate_token_tree__sampling_kernel,@function
standalone__tree_speculative_verify_tree_attention_over_candidate_token_tree__sampling_kernel:
    s_cmp_ge_u32 s2, 256
    s_cbranch_scc1 L_end
    s_load_dwordx16 s[16:31], s[0:1], 0
    v_lshrrev_b32 v1, 6, v0
    v_and_b32 v0, 63, v0
    v_readfirstlane_b32 s3, v1
    s_and_b32 s6, s2, 7
    s_lshr_b32 s7, s2, 3
    s_and_b32 s5, s7, 1
    s_lshr_b32 s7, s7, 1
    s_lshl_b32 s7, s7, 3
    s_or_b32 s4, s7, s6
    v_and_b32 v24, 15, v0
    v_lshrrev_b32 v25, 4, v0
    v_lshlrev_b32 v240, 4, v0
    v_lshlrev_b32 v241, 6, v24
    v_lshl_or_b32 v241, v25, 3, v241
    s_lshr_b32 s8, s3, 1
    s_and_b32 s9, s3, 1
    s_lshl_b32 s10, s8, 15
    s_lshl_b32 s11, s9, 12
    s_lshl_b32 s73, s3, 12
    s_lshl_b32 s6, s4, 19
    s_lshl_b32 s7, s4, 16
    s_lshl_b32 s12, s5, 15
    s_add_u32 s7, s7, s12
    s_lshl_b32 s12, s4, 13
    s_lshr_b32 s13, s4, 2
    s_lshl_b32 s13, s13, 11
    s_lshl_b32 s14, s3, 13
    s_add_u32 s15, s14, 4096
    v_xor_b32 v26, v24, v25
    v_lshlrev_b32 v27, 8, v25
    v_lshl_or_b32 v14, v26, 4, v27
    v_xor_b32 v15, 64, v14
    v_xor_b32 v16, 128, v14
    v_xor_b32 v17, 192, v14
    s_add_u32 s66, s10, s11
    s_add_u32 s67, s66, 65536
    s_mov_b32 s64, s73
    s_mov_b32 s65, s73
    s_waitcnt lgkmcnt(0)
    s_add_u32 s56, s26, s13
    s_addc_u32 s57, s27, 0
    s_and_b32 s57, s57, 0xffff
    s_mov_b32 s58, 2048
    s_mov_b32 s59, 0x00020000
    buffer_load_dwordx2 v[232:233], v241, s[56:59], 0 offen offset:0
    buffer_load_dwordx2 v[234:235], v241, s[56:59], 0 offen offset:32
    buffer_load_dwordx2 v[236:237], v241, s[56:59], 0 offen offset:1024
    buffer_load_dwordx2 v[238:239], v241, s[56:59], 0 offen offset:1056
    s_add_u32 s44, s16, s7
    s_addc_u32 s45, s17, 0
    s_and_b32 s45, s45, 0xffff
    s_mov_b32 s46, 32768
    s_mov_b32 s47, 0x00020000
    buffer_load_dwordx4 v[32:35], v240, s[44:47], s14 offen offset:0
    buffer_load_dwordx4 v[36:39], v240, s[44:47], s14 offen offset:1024
    buffer_load_dwordx4 v[40:43], v240, s[44:47], s14 offen offset:2048
    buffer_load_dwordx4 v[44:47], v240, s[44:47], s14 offen offset:3072
    buffer_load_dwordx4 v[48:51], v240, s[44:47], s15 offen offset:0
    buffer_load_dwordx4 v[52:55], v240, s[44:47], s15 offen offset:1024
    buffer_load_dwordx4 v[56:59], v240, s[44:47], s15 offen offset:2048
    buffer_load_dwordx4 v[60:63], v240, s[44:47], s15 offen offset:3072
    s_add_u32 s36, s18, s6
    s_addc_u32 s37, s19, 0
    s_and_b32 s37, s37, 0xffff
    s_mov_b32 s38, 524288
    s_mov_b32 s39, 0x00020000
    s_add_u32 m0, s66, 0
    s_nop 0
    buffer_load_dwordx4 v14, s[36:39], s64 offen offset:0 nt lds
    buffer_load_dwordx4 v15, s[36:39], s64 offen offset:1024 nt lds
    buffer_load_dwordx4 v16, s[36:39], s64 offen offset:2048 nt lds
    buffer_load_dwordx4 v17, s[36:39], s64 offen offset:3072 nt lds
    s_add_u32 s64, s64, 16384
    s_add_u32 s40, s20, s6
    s_addc_u32 s41, s21, 0
    s_and_b32 s41, s41, 0xffff
    s_mov_b32 s42, 524288
    s_mov_b32 s43, 0x00020000
    s_add_u32 s48, s22, s12
    s_addc_u32 s49, s23, 0
    s_and_b32 s49, s49, 0xffff
    s_mov_b32 s50, 8192
    s_mov_b32 s51, 0x00020000
    s_add_u32 s52, s24, s12
    s_addc_u32 s53, s25, 0
    s_and_b32 s53, s53, 0xffff
    s_mov_b32 s54, 8192
    s_mov_b32 s55, 0x00020000
    s_add_u32 s60, s28, s7
    s_addc_u32 s61, s29, 0
    s_and_b32 s61, s61, 0xffff
    s_mov_b32 s62, 32768
    s_mov_b32 s63, 0x00020000
    v_lshlrev_b32 v28, 1, v25
    v_xor_b32 v28, v24, v28
    v_lshl_or_b32 v18, v28, 4, v27
    v_xor_b32 v19, 0x80, v18
    v_lshlrev_b32 v28, 8, v24
    v_lshl_or_b32 v2, v26, 4, v28
    v_add_u32 v2, s10, v2
    v_xor_b32 v3, 64, v2
    v_xor_b32 v4, 128, v2
    v_xor_b32 v5, 192, v2
    v_lshrrev_b32 v28, 2, v0
    v_and_b32 v29, 7, v28
    v_lshlrev_b32 v28, 8, v28
    v_lshl_or_b32 v28, v29, 5, v28
    v_and_b32 v29, 3, v0
    v_lshl_or_b32 v28, v29, 3, v28
    s_add_u32 s14, s10, 65536
    v_add_u32 v6, s14, v28
    v_xor_b32 v7, 32, v6
    v_xor_b32 v8, 64, v6
    v_xor_b32 v9, 96, v6
    v_xor_b32 v10, 128, v6
    v_xor_b32 v11, 160, v6
    v_xor_b32 v12, 192, v6
    v_xor_b32 v13, 224, v6
    s_mov_b32 s69, 0x46800000
    s_mov_b32 s68, 0
    s_mov_b32 s74, s11
    s_lshl_b32 s12, s9, 1
    s_add_u32 s13, s12, s8
    s_lshl_b32 s71, s13, 13
    s_xor_b32 s13, s13, 1
    s_lshl_b32 s72, s13, 13
    s_lshl_b32 s14, s3, 13
    s_add_u32 s14, s14, 131072
    v_add_u32 v242, s14, v14
    v_add_u32 v243, s14, v15
    v_add_u32 v244, s14, v16
    v_add_u32 v245, s14, v17
    s_sub_u32 s15, 131072, s10
    s_add_u32 s14, s15, s71
    v_add_u32 v144, s14, v2
    v_add_u32 v145, s14, v3
    v_add_u32 v146, s14, v4
    v_add_u32 v147, s14, v5
    s_add_u32 s14, s15, s72
    v_add_u32 v148, s14, v2
    v_add_u32 v149, s14, v3
    v_add_u32 v150, s14, v4
    v_add_u32 v151, s14, v5
    s_mov_b32 s14, 0x3e0293ee
    s_mov_b32 s15, 0x3e0293ee
    v_mov_b32 v160, 0
    v_mov_b32 v161, 0
    v_mov_b32 v162, 0
    v_mov_b32 v163, 0
    v_mov_b32 v164, 0
    v_mov_b32 v165, 0
    v_mov_b32 v166, 0
    v_mov_b32 v167, 0
    v_mov_b32 v168, 0
    v_mov_b32 v169, 0
    v_mov_b32 v170, 0
    v_mov_b32 v171, 0
    v_mov_b32 v172, 0
    v_mov_b32 v173, 0
    v_mov_b32 v174, 0
    v_mov_b32 v175, 0
    v_mov_b32 v176, 0
    v_mov_b32 v177, 0
    v_mov_b32 v178, 0
    v_mov_b32 v179, 0
    v_mov_b32 v180, 0
    v_mov_b32 v181, 0
    v_mov_b32 v182, 0
    v_mov_b32 v183, 0
    v_mov_b32 v184, 0
    v_mov_b32 v185, 0
    v_mov_b32 v186, 0
    v_mov_b32 v187, 0
    v_mov_b32 v188, 0
    v_mov_b32 v189, 0
    v_mov_b32 v190, 0
    v_mov_b32 v191, 0
    v_mov_b32 v192, 0
    v_mov_b32 v193, 0
    v_mov_b32 v194, 0
    v_mov_b32 v195, 0
    v_mov_b32 v196, 0
    v_mov_b32 v197, 0
    v_mov_b32 v198, 0
    v_mov_b32 v199, 0
    v_mov_b32 v200, 0
    v_mov_b32 v201, 0
    v_mov_b32 v202, 0
    v_mov_b32 v203, 0
    v_mov_b32 v204, 0
    v_mov_b32 v205, 0
    v_mov_b32 v206, 0
    v_mov_b32 v207, 0
    v_mov_b32 v208, 0
    v_mov_b32 v209, 0
    v_mov_b32 v210, 0
    v_mov_b32 v211, 0
    v_mov_b32 v212, 0
    v_mov_b32 v213, 0
    v_mov_b32 v214, 0
    v_mov_b32 v215, 0
    v_mov_b32 v216, 0
    v_mov_b32 v217, 0
    v_mov_b32 v218, 0
    v_mov_b32 v219, 0
    v_mov_b32 v220, 0
    v_mov_b32 v221, 0
    v_mov_b32 v222, 0
    v_mov_b32 v223, 0
    v_accvgpr_write_b32 a0, 0
    v_accvgpr_write_b32 a1, 0
    v_accvgpr_write_b32 a2, 0
    v_accvgpr_write_b32 a3, 0
    v_accvgpr_write_b32 a4, 0
    v_accvgpr_write_b32 a5, 0
    v_accvgpr_write_b32 a6, 0
    v_accvgpr_write_b32 a7, 0
    v_accvgpr_write_b32 a8, 0
    v_accvgpr_write_b32 a9, 0
    v_accvgpr_write_b32 a10, 0
    v_accvgpr_write_b32 a11, 0
    v_accvgpr_write_b32 a12, 0
    v_accvgpr_write_b32 a13, 0
    v_accvgpr_write_b32 a14, 0
    v_accvgpr_write_b32 a15, 0
    v_accvgpr_write_b32 a16, 0
    v_accvgpr_write_b32 a17, 0
    v_accvgpr_write_b32 a18, 0
    v_accvgpr_write_b32 a19, 0
    v_accvgpr_write_b32 a20, 0
    v_accvgpr_write_b32 a21, 0
    v_accvgpr_write_b32 a22, 0
    v_accvgpr_write_b32 a23, 0
    v_accvgpr_write_b32 a24, 0
    v_accvgpr_write_b32 a25, 0
    v_accvgpr_write_b32 a26, 0
    v_accvgpr_write_b32 a27, 0
    v_accvgpr_write_b32 a28, 0
    v_accvgpr_write_b32 a29, 0
    v_accvgpr_write_b32 a30, 0
    v_accvgpr_write_b32 a31, 0
    v_accvgpr_write_b32 a32, 0
    v_accvgpr_write_b32 a33, 0
    v_accvgpr_write_b32 a34, 0
    v_accvgpr_write_b32 a35, 0
    v_accvgpr_write_b32 a36, 0
    v_accvgpr_write_b32 a37, 0
    v_accvgpr_write_b32 a38, 0
    v_accvgpr_write_b32 a39, 0
    v_accvgpr_write_b32 a40, 0
    v_accvgpr_write_b32 a41, 0
    v_accvgpr_write_b32 a42, 0
    v_accvgpr_write_b32 a43, 0
    v_accvgpr_write_b32 a44, 0
    v_accvgpr_write_b32 a45, 0
    v_accvgpr_write_b32 a46, 0
    v_accvgpr_write_b32 a47, 0
    v_accvgpr_write_b32 a48, 0
    v_accvgpr_write_b32 a49, 0
    v_accvgpr_write_b32 a50, 0
    v_accvgpr_write_b32 a51, 0
    v_accvgpr_write_b32 a52, 0
    v_accvgpr_write_b32 a53, 0
    v_accvgpr_write_b32 a54, 0
    v_accvgpr_write_b32 a55, 0
    v_accvgpr_write_b32 a56, 0
    v_accvgpr_write_b32 a57, 0
    v_accvgpr_write_b32 a58, 0
    v_accvgpr_write_b32 a59, 0
    v_accvgpr_write_b32 a60, 0
    v_accvgpr_write_b32 a61, 0
    v_accvgpr_write_b32 a62, 0
    v_accvgpr_write_b32 a63, 0
    v_mov_b32 v20, 0
    v_mov_b32 v248, 0x3f803f80
    v_mov_b32 v21, 0
    v_mov_b32 v249, 0x3f803f80
    v_mov_b32 v22, 0
    v_mov_b32 v250, 0x3f803f80
    v_mov_b32 v23, 0
    v_mov_b32 v251, 0x3f803f80
    s_mov_b32 s12, 0xce6e6b28
    s_mov_b32 s13, 0x3fb8aa3b
    s_waitcnt vmcnt(12)
    v_lshlrev_b32 v24, 16, v232
    v_and_b32 v25, 0xffff0000, v232
    v_sub_f32 v24, 1.0, v24
    v_mul_f32 v24, s12, v24
    v_mul_f32 v224, s13, v24
    v_sub_f32 v25, 1.0, v25
    v_mul_f32 v25, s12, v25
    v_mul_f32 v225, s13, v25
    v_lshlrev_b32 v26, 16, v233
    v_and_b32 v27, 0xffff0000, v233
    v_sub_f32 v26, 1.0, v26
    v_mul_f32 v26, s12, v26
    v_mul_f32 v226, s13, v26
    v_sub_f32 v27, 1.0, v27
    v_mul_f32 v27, s12, v27
    v_mul_f32 v227, s13, v27
    v_lshlrev_b32 v24, 16, v234
    v_and_b32 v25, 0xffff0000, v234
    v_sub_f32 v24, 1.0, v24
    v_mul_f32 v24, s12, v24
    v_mul_f32 v228, s13, v24
    v_sub_f32 v25, 1.0, v25
    v_mul_f32 v25, s12, v25
    v_mul_f32 v229, s13, v25
    v_lshlrev_b32 v26, 16, v235
    v_and_b32 v27, 0xffff0000, v235
    v_sub_f32 v26, 1.0, v26
    v_mul_f32 v26, s12, v26
    v_mul_f32 v230, s13, v26
    v_sub_f32 v27, 1.0, v27
    v_mul_f32 v27, s12, v27
    v_mul_f32 v231, s13, v27
    v_lshlrev_b32 v24, 16, v236
    v_and_b32 v25, 0xffff0000, v236
    v_sub_f32 v24, 1.0, v24
    v_mul_f32 v24, s12, v24
    v_mul_f32 v232, s13, v24
    v_sub_f32 v25, 1.0, v25
    v_mul_f32 v25, s12, v25
    v_mul_f32 v233, s13, v25
    v_lshlrev_b32 v26, 16, v237
    v_and_b32 v27, 0xffff0000, v237
    v_sub_f32 v26, 1.0, v26
    v_mul_f32 v26, s12, v26
    v_mul_f32 v234, s13, v26
    v_sub_f32 v27, 1.0, v27
    v_mul_f32 v27, s12, v27
    v_mul_f32 v235, s13, v27
    v_lshlrev_b32 v24, 16, v238
    v_and_b32 v25, 0xffff0000, v238
    v_sub_f32 v24, 1.0, v24
    v_mul_f32 v24, s12, v24
    v_mul_f32 v236, s13, v24
    v_sub_f32 v25, 1.0, v25
    v_mul_f32 v25, s12, v25
    v_mul_f32 v237, s13, v25
    v_lshlrev_b32 v26, 16, v239
    v_and_b32 v27, 0xffff0000, v239
    v_sub_f32 v26, 1.0, v26
    v_mul_f32 v26, s12, v26
    v_mul_f32 v238, s13, v26
    v_sub_f32 v27, 1.0, v27
    v_mul_f32 v27, s12, v27
    v_mul_f32 v239, s13, v27
    s_add_u32 m0, s66, 8192
    s_nop 0
    buffer_load_dwordx4 v14, s[36:39], s64 offen offset:0 nt lds
    buffer_load_dwordx4 v15, s[36:39], s64 offen offset:1024 nt lds
    buffer_load_dwordx4 v16, s[36:39], s64 offen offset:2048 nt lds
    buffer_load_dwordx4 v17, s[36:39], s64 offen offset:3072 nt lds
    s_add_u32 s64, s64, 16384
    s_waitcnt vmcnt(15)
    v_lshlrev_b32 v24, 16, v32
    v_and_b32 v25, 0xffff0000, v32
    v_pk_mul_f32 v[24:25], v[24:25], s[14:15]
    v_cvt_pk_bf16_f32 v32, v24, v25
    v_lshlrev_b32 v26, 16, v33
    v_and_b32 v27, 0xffff0000, v33
    v_pk_mul_f32 v[26:27], v[26:27], s[14:15]
    v_cvt_pk_bf16_f32 v33, v26, v27
    v_lshlrev_b32 v28, 16, v34
    v_and_b32 v29, 0xffff0000, v34
    v_pk_mul_f32 v[28:29], v[28:29], s[14:15]
    v_cvt_pk_bf16_f32 v34, v28, v29
    v_lshlrev_b32 v24, 16, v35
    v_and_b32 v25, 0xffff0000, v35
    v_pk_mul_f32 v[24:25], v[24:25], s[14:15]
    v_cvt_pk_bf16_f32 v35, v24, v25
    ds_write_b128 v242, v[32:35] offset:0
    s_waitcnt vmcnt(14)
    v_lshlrev_b32 v24, 16, v36
    v_and_b32 v25, 0xffff0000, v36
    v_pk_mul_f32 v[24:25], v[24:25], s[14:15]
    v_cvt_pk_bf16_f32 v36, v24, v25
    v_lshlrev_b32 v26, 16, v37
    v_and_b32 v27, 0xffff0000, v37
    v_pk_mul_f32 v[26:27], v[26:27], s[14:15]
    v_cvt_pk_bf16_f32 v37, v26, v27
    v_lshlrev_b32 v28, 16, v38
    v_and_b32 v29, 0xffff0000, v38
    v_pk_mul_f32 v[28:29], v[28:29], s[14:15]
    v_cvt_pk_bf16_f32 v38, v28, v29
    v_lshlrev_b32 v24, 16, v39
    v_and_b32 v25, 0xffff0000, v39
    v_pk_mul_f32 v[24:25], v[24:25], s[14:15]
    v_cvt_pk_bf16_f32 v39, v24, v25
    ds_write_b128 v243, v[36:39] offset:1024
    s_add_u32 m0, s67, 0
    s_nop 0
    buffer_load_dwordx4 v18, s[40:43], s65 offen offset:0 nt lds
    s_waitcnt vmcnt(14)
    v_lshlrev_b32 v24, 16, v40
    v_and_b32 v25, 0xffff0000, v40
    v_pk_mul_f32 v[24:25], v[24:25], s[14:15]
    v_cvt_pk_bf16_f32 v40, v24, v25
    v_lshlrev_b32 v26, 16, v41
    v_and_b32 v27, 0xffff0000, v41
    v_pk_mul_f32 v[26:27], v[26:27], s[14:15]
    v_cvt_pk_bf16_f32 v41, v26, v27
    v_lshlrev_b32 v28, 16, v42
    v_and_b32 v29, 0xffff0000, v42
    v_pk_mul_f32 v[28:29], v[28:29], s[14:15]
    v_cvt_pk_bf16_f32 v42, v28, v29
    v_lshlrev_b32 v24, 16, v43
    v_and_b32 v25, 0xffff0000, v43
    v_pk_mul_f32 v[24:25], v[24:25], s[14:15]
    v_cvt_pk_bf16_f32 v43, v24, v25
    ds_write_b128 v244, v[40:43] offset:2048
    s_waitcnt vmcnt(13)
    v_lshlrev_b32 v24, 16, v44
    v_and_b32 v25, 0xffff0000, v44
    v_pk_mul_f32 v[24:25], v[24:25], s[14:15]
    v_cvt_pk_bf16_f32 v44, v24, v25
    v_lshlrev_b32 v26, 16, v45
    v_and_b32 v27, 0xffff0000, v45
    v_pk_mul_f32 v[26:27], v[26:27], s[14:15]
    v_cvt_pk_bf16_f32 v45, v26, v27
    v_lshlrev_b32 v28, 16, v46
    v_and_b32 v29, 0xffff0000, v46
    v_pk_mul_f32 v[28:29], v[28:29], s[14:15]
    v_cvt_pk_bf16_f32 v46, v28, v29
    v_lshlrev_b32 v24, 16, v47
    v_and_b32 v25, 0xffff0000, v47
    v_pk_mul_f32 v[24:25], v[24:25], s[14:15]
    v_cvt_pk_bf16_f32 v47, v24, v25
    ds_write_b128 v245, v[44:47] offset:3072
    buffer_load_dwordx4 v19, s[40:43], s65 offen offset:1024 nt lds
    s_waitcnt vmcnt(13)
    v_lshlrev_b32 v24, 16, v48
    v_and_b32 v25, 0xffff0000, v48
    v_pk_mul_f32 v[24:25], v[24:25], s[14:15]
    v_cvt_pk_bf16_f32 v48, v24, v25
    v_lshlrev_b32 v26, 16, v49
    v_and_b32 v27, 0xffff0000, v49
    v_pk_mul_f32 v[26:27], v[26:27], s[14:15]
    v_cvt_pk_bf16_f32 v49, v26, v27
    v_lshlrev_b32 v28, 16, v50
    v_and_b32 v29, 0xffff0000, v50
    v_pk_mul_f32 v[28:29], v[28:29], s[14:15]
    v_cvt_pk_bf16_f32 v50, v28, v29
    v_lshlrev_b32 v24, 16, v51
    v_and_b32 v25, 0xffff0000, v51
    v_pk_mul_f32 v[24:25], v[24:25], s[14:15]
    v_cvt_pk_bf16_f32 v51, v24, v25
    ds_write_b128 v242, v[48:51] offset:4096
    s_waitcnt vmcnt(12)
    v_lshlrev_b32 v24, 16, v52
    v_and_b32 v25, 0xffff0000, v52
    v_pk_mul_f32 v[24:25], v[24:25], s[14:15]
    v_cvt_pk_bf16_f32 v52, v24, v25
    v_lshlrev_b32 v26, 16, v53
    v_and_b32 v27, 0xffff0000, v53
    v_pk_mul_f32 v[26:27], v[26:27], s[14:15]
    v_cvt_pk_bf16_f32 v53, v26, v27
    v_lshlrev_b32 v28, 16, v54
    v_and_b32 v29, 0xffff0000, v54
    v_pk_mul_f32 v[28:29], v[28:29], s[14:15]
    v_cvt_pk_bf16_f32 v54, v28, v29
    v_lshlrev_b32 v24, 16, v55
    v_and_b32 v25, 0xffff0000, v55
    v_pk_mul_f32 v[24:25], v[24:25], s[14:15]
    v_cvt_pk_bf16_f32 v55, v24, v25
    ds_write_b128 v243, v[52:55] offset:5120
    buffer_load_dwordx4 v18, s[40:43], s65 offen offset:2048 nt lds
    s_waitcnt vmcnt(12)
    v_lshlrev_b32 v24, 16, v56
    v_and_b32 v25, 0xffff0000, v56
    v_pk_mul_f32 v[24:25], v[24:25], s[14:15]
    v_cvt_pk_bf16_f32 v56, v24, v25
    v_lshlrev_b32 v26, 16, v57
    v_and_b32 v27, 0xffff0000, v57
    v_pk_mul_f32 v[26:27], v[26:27], s[14:15]
    v_cvt_pk_bf16_f32 v57, v26, v27
    v_lshlrev_b32 v28, 16, v58
    v_and_b32 v29, 0xffff0000, v58
    v_pk_mul_f32 v[28:29], v[28:29], s[14:15]
    v_cvt_pk_bf16_f32 v58, v28, v29
    v_lshlrev_b32 v24, 16, v59
    v_and_b32 v25, 0xffff0000, v59
    v_pk_mul_f32 v[24:25], v[24:25], s[14:15]
    v_cvt_pk_bf16_f32 v59, v24, v25
    ds_write_b128 v244, v[56:59] offset:6144
    s_waitcnt vmcnt(11)
    v_lshlrev_b32 v24, 16, v60
    v_and_b32 v25, 0xffff0000, v60
    v_pk_mul_f32 v[24:25], v[24:25], s[14:15]
    v_cvt_pk_bf16_f32 v60, v24, v25
    v_lshlrev_b32 v26, 16, v61
    v_and_b32 v27, 0xffff0000, v61
    v_pk_mul_f32 v[26:27], v[26:27], s[14:15]
    v_cvt_pk_bf16_f32 v61, v26, v27
    v_lshlrev_b32 v28, 16, v62
    v_and_b32 v29, 0xffff0000, v62
    v_pk_mul_f32 v[28:29], v[28:29], s[14:15]
    v_cvt_pk_bf16_f32 v62, v28, v29
    v_lshlrev_b32 v24, 16, v63
    v_and_b32 v25, 0xffff0000, v63
    v_pk_mul_f32 v[24:25], v[24:25], s[14:15]
    v_cvt_pk_bf16_f32 v63, v24, v25
    ds_write_b128 v245, v[60:63] offset:7168
    buffer_load_dwordx4 v19, s[40:43], s65 offen offset:3072 nt lds
    s_add_u32 s65, s65, 16384
    s_waitcnt vmcnt(8) lgkmcnt(0)
    s_barrier
    ds_read_b128 a[64:67], v144 offset:0
    ds_read_b128 a[68:71], v145 offset:0
    ds_read_b128 a[72:75], v146 offset:0
    ds_read_b128 a[76:79], v147 offset:0
    ds_read_b128 a[128:131], v2 offset:0
    ds_read_b128 a[132:135], v3 offset:0
    ds_read_b128 a[136:139], v4 offset:0
    ds_read_b128 a[140:143], v5 offset:0
    ds_read_b128 a[144:147], v2 offset:4096
    ds_read_b128 a[148:151], v3 offset:4096
    ds_read_b128 a[152:155], v4 offset:4096
    ds_read_b128 a[156:159], v5 offset:4096
    ds_read_b128 a[80:83], v144 offset:4096
    ds_read_b128 a[84:87], v145 offset:4096
    s_waitcnt lgkmcnt(6)
    v_mfma_f32_16x16x32_bf16 v[32:35], a[128:131], a[64:67], 0
    ds_read_b128 a[88:91], v146 offset:4096
    v_mfma_f32_16x16x32_bf16 v[32:35], a[132:135], a[68:71], v[32:35]
    ds_read_b128 a[92:95], v147 offset:4096
    s_add_u32 m0, s66, 16384
    s_nop 0
    buffer_load_dwordx4 v14, s[36:39], s64 offen offset:0 nt lds
    v_mfma_f32_16x16x32_bf16 v[32:35], a[136:139], a[72:75], v[32:35]
    ds_read_b128 a[96:99], v148 offset:0
    v_mfma_f32_16x16x32_bf16 v[32:35], a[140:143], a[76:79], v[32:35]
    ds_read_b128 a[100:103], v149 offset:0
    s_waitcnt lgkmcnt(6)
    v_mfma_f32_16x16x32_bf16 v[36:39], a[144:147], a[64:67], 0
    ds_read_b128 a[104:107], v150 offset:0
    v_mfma_f32_16x16x32_bf16 v[36:39], a[148:151], a[68:71], v[36:39]
    ds_read_b128 a[108:111], v151 offset:0
    buffer_load_dwordx4 v15, s[36:39], s64 offen offset:1024 nt lds
    v_mfma_f32_16x16x32_bf16 v[36:39], a[152:155], a[72:75], v[36:39]
    ds_read_b128 a[112:115], v148 offset:4096
    v_mfma_f32_16x16x32_bf16 v[36:39], a[156:159], a[76:79], v[36:39]
    ds_read_b128 a[116:119], v149 offset:4096
    s_waitcnt lgkmcnt(6)
    v_mfma_f32_16x16x32_bf16 v[40:43], a[128:131], a[80:83], 0
    ds_read_b128 a[120:123], v150 offset:4096
    v_mfma_f32_16x16x32_bf16 v[40:43], a[132:135], a[84:87], v[40:43]
    ds_read_b128 a[124:127], v151 offset:4096
    buffer_load_dwordx4 v16, s[36:39], s64 offen offset:2048 nt lds
    v_mfma_f32_16x16x32_bf16 v[40:43], a[136:139], a[88:91], v[40:43]
    v_mfma_f32_16x16x32_bf16 v[40:43], a[140:143], a[92:95], v[40:43]
    v_mfma_f32_16x16x32_bf16 v[44:47], a[144:147], a[80:83], 0
    v_mfma_f32_16x16x32_bf16 v[44:47], a[148:151], a[84:87], v[44:47]
    buffer_load_dwordx4 v17, s[36:39], s64 offen offset:3072 nt lds
    s_add_u32 s64, s64, 16384
    v_mfma_f32_16x16x32_bf16 v[44:47], a[152:155], a[88:91], v[44:47]
    v_mfma_f32_16x16x32_bf16 v[44:47], a[156:159], a[92:95], v[44:47]
    s_waitcnt lgkmcnt(4)
    v_mfma_f32_16x16x32_bf16 v[48:51], a[128:131], a[96:99], 0
    v_mfma_f32_16x16x32_bf16 v[48:51], a[132:135], a[100:103], v[48:51]
    s_add_u32 m0, s67, 8192
    s_nop 0
    buffer_load_dwordx4 v18, s[40:43], s65 offen offset:0 nt lds
    v_mfma_f32_16x16x32_bf16 v[48:51], a[136:139], a[104:107], v[48:51]
    v_mfma_f32_16x16x32_bf16 v[48:51], a[140:143], a[108:111], v[48:51]
    v_mfma_f32_16x16x32_bf16 v[52:55], a[144:147], a[96:99], 0
    v_max3_f32 v152, v32, v33, v34
    v_max3_f32 v152, v152, v35, v36
    v_mfma_f32_16x16x32_bf16 v[52:55], a[148:151], a[100:103], v[52:55]
    v_max3_f32 v152, v152, v37, v38
    v_max_f32 v152, v152, v39
    buffer_load_dwordx4 v19, s[40:43], s65 offen offset:1024 nt lds
    v_mfma_f32_16x16x32_bf16 v[52:55], a[152:155], a[104:107], v[52:55]
    v_mfma_f32_16x16x32_bf16 v[52:55], a[156:159], a[108:111], v[52:55]
    s_waitcnt lgkmcnt(0)
    v_mfma_f32_16x16x32_bf16 v[56:59], a[128:131], a[112:115], 0
    v_mfma_f32_16x16x32_bf16 v[56:59], a[132:135], a[116:119], v[56:59]
    buffer_load_dwordx4 v18, s[40:43], s65 offen offset:2048 nt lds
    v_mfma_f32_16x16x32_bf16 v[56:59], a[136:139], a[120:123], v[56:59]
    v_mfma_f32_16x16x32_bf16 v[56:59], a[140:143], a[124:127], v[56:59]
    v_mfma_f32_16x16x32_bf16 v[60:63], a[144:147], a[112:115], 0
    v_max3_f32 v153, v40, v41, v42
    v_max3_f32 v153, v153, v43, v44
    v_mfma_f32_16x16x32_bf16 v[60:63], a[148:151], a[116:119], v[60:63]
    v_max3_f32 v153, v153, v45, v46
    v_max_f32 v153, v153, v47
    buffer_load_dwordx4 v19, s[40:43], s65 offen offset:3072 nt lds
    s_add_u32 s65, s65, 16384
    v_mfma_f32_16x16x32_bf16 v[60:63], a[152:155], a[120:123], v[60:63]
    v_mfma_f32_16x16x32_bf16 v[60:63], a[156:159], a[124:127], v[60:63]
    v_mov_b32 v24, v152
    v_mov_b32 v25, v152
    s_nop 1
    v_permlane16_swap_b32 v24, v25
    s_nop 1
    v_max_f32 v152, v24, v25
    v_mov_b32 v24, v152
    v_mov_b32 v25, v152
    s_nop 1
    v_permlane32_swap_b32 v24, v25
    s_nop 1
    v_max_f32 v152, v24, v25
    v_sub_f32 v96, 0, v152
    v_sub_f32 v97, 0, v152
    v_sub_f32 v98, 0, v152
    v_sub_f32 v99, 0, v152
    v_sub_f32 v32, v32, v152
    v_sub_f32 v33, v33, v152
    v_sub_f32 v34, v34, v152
    v_sub_f32 v35, v35, v152
    v_sub_f32 v36, v36, v152
    v_sub_f32 v37, v37, v152
    v_sub_f32 v38, v38, v152
    v_sub_f32 v39, v39, v152
    s_add_u32 m0, s66, 24576
    s_nop 0
    buffer_load_dwordx4 v14, s[36:39], s64 offen offset:0 nt lds
    v_mov_b32 v24, v153
    v_mov_b32 v25, v153
    s_nop 1
    v_permlane16_swap_b32 v24, v25
    s_nop 1
    v_max_f32 v153, v24, v25
    v_mov_b32 v24, v153
    v_mov_b32 v25, v153
    s_nop 1
    v_permlane32_swap_b32 v24, v25
    s_nop 1
    v_max_f32 v153, v24, v25
    v_sub_f32 v100, 0, v153
    v_sub_f32 v101, 0, v153
    v_sub_f32 v102, 0, v153
    v_sub_f32 v103, 0, v153
    v_sub_f32 v40, v40, v153
    v_sub_f32 v41, v41, v153
    v_sub_f32 v42, v42, v153
    v_sub_f32 v43, v43, v153
    v_sub_f32 v44, v44, v153
    v_sub_f32 v45, v45, v153
    v_sub_f32 v46, v46, v153
    v_sub_f32 v47, v47, v153
    buffer_load_dwordx4 v15, s[36:39], s64 offen offset:1024 nt lds
    s_waitcnt vmcnt(10)
    s_barrier
    ds_read_b128 a[128:131], v2 offset:8192
    ds_read_b128 a[132:135], v3 offset:8192
    ds_read_b128 a[136:139], v4 offset:8192
    ds_read_b128 a[140:143], v5 offset:8192
    ds_read_b128 a[144:147], v2 offset:12288
    ds_read_b128 a[148:151], v3 offset:12288
    ds_read_b128 a[152:155], v4 offset:12288
    ds_read_b128 a[156:159], v5 offset:12288
    v_max3_f32 v154, v48, v49, v50
    v_max3_f32 v154, v154, v51, v52
    v_max3_f32 v154, v154, v53, v54
    v_max_f32 v154, v154, v55
    v_mov_b32 v24, v154
    v_mov_b32 v25, v154
    s_nop 1
    v_permlane16_swap_b32 v24, v25
    s_nop 1
    v_max_f32 v154, v24, v25
    v_mov_b32 v24, v154
    v_mov_b32 v25, v154
    s_nop 1
    v_permlane32_swap_b32 v24, v25
    s_nop 1
    v_max_f32 v154, v24, v25
    v_sub_f32 v104, 0, v154
    v_sub_f32 v105, 0, v154
    v_sub_f32 v106, 0, v154
    v_sub_f32 v107, 0, v154
    v_sub_f32 v48, v48, v154
    v_sub_f32 v49, v49, v154
    v_sub_f32 v50, v50, v154
    v_sub_f32 v51, v51, v154
    v_sub_f32 v52, v52, v154
    v_sub_f32 v53, v53, v154
    v_sub_f32 v54, v54, v154
    v_sub_f32 v55, v55, v154
    buffer_load_dwordx4 v16, s[36:39], s64 offen offset:2048 nt lds
    v_max3_f32 v155, v56, v57, v58
    v_max3_f32 v155, v155, v59, v60
    v_max3_f32 v155, v155, v61, v62
    v_max_f32 v155, v155, v63
    v_mov_b32 v24, v155
    v_mov_b32 v25, v155
    s_nop 1
    v_permlane16_swap_b32 v24, v25
    s_nop 1
    v_max_f32 v155, v24, v25
    v_mov_b32 v24, v155
    v_mov_b32 v25, v155
    s_nop 1
    v_permlane32_swap_b32 v24, v25
    s_nop 1
    v_max_f32 v155, v24, v25
    v_sub_f32 v108, 0, v155
    v_sub_f32 v109, 0, v155
    v_sub_f32 v110, 0, v155
    v_sub_f32 v111, 0, v155
    v_sub_f32 v56, v56, v155
    v_sub_f32 v57, v57, v155
    v_sub_f32 v58, v58, v155
    v_sub_f32 v59, v59, v155
    v_sub_f32 v60, v60, v155
    v_sub_f32 v61, v61, v155
    v_sub_f32 v62, v62, v155
    v_sub_f32 v63, v63, v155
    buffer_load_dwordx4 v17, s[36:39], s64 offen offset:3072 nt lds
    s_add_u32 s64, s64, 16384
    s_waitcnt lgkmcnt(0)
    v_mfma_f32_16x16x32_bf16 v[64:67], a[128:131], a[64:67], v[96:99]
    v_exp_f32 v24, v32
    v_mfma_f32_16x16x32_bf16 v[64:67], a[132:135], a[68:71], v[64:67]
    v_exp_f32 v25, v33
    v_mfma_f32_16x16x32_bf16 v[64:67], a[136:139], a[72:75], v[64:67]
    v_exp_f32 v26, v34
    v_mfma_f32_16x16x32_bf16 v[64:67], a[140:143], a[76:79], v[64:67]
    v_exp_f32 v27, v35
    s_add_u32 m0, s67, 16384
    s_nop 0
    buffer_load_dwordx4 v18, s[40:43], s65 offen offset:0 nt lds
    v_mfma_f32_16x16x32_bf16 v[68:71], a[144:147], a[64:67], v[96:99]
    ds_read_b64_tr_b16 a[192:193], v6 offset:0
    v_cvt_pk_bf16_f32 v128, v24, v25
    v_mfma_f32_16x16x32_bf16 v[68:71], a[148:151], a[68:71], v[68:71]
    v_exp_f32 v28, v36
    v_mfma_f32_16x16x32_bf16 v[68:71], a[152:155], a[72:75], v[68:71]
    v_exp_f32 v29, v37
    v_mfma_f32_16x16x32_bf16 v[68:71], a[156:159], a[76:79], v[68:71]
    ds_read_b64_tr_b16 a[194:195], v6 offset:4096
    v_cvt_pk_bf16_f32 v129, v26, v27
    buffer_load_dwordx4 v19, s[40:43], s65 offen offset:1024 nt lds
    v_mfma_f32_16x16x32_bf16 v[72:75], a[128:131], a[80:83], v[100:103]
    v_exp_f32 v30, v38
    v_mfma_f32_16x16x32_bf16 v[72:75], a[132:135], a[84:87], v[72:75]
    v_exp_f32 v31, v39
    v_mfma_f32_16x16x32_bf16 v[72:75], a[136:139], a[88:91], v[72:75]
    ds_read_b64_tr_b16 a[196:197], v7 offset:0
    v_cvt_pk_bf16_f32 v130, v28, v29
    v_mfma_f32_16x16x32_bf16 v[72:75], a[140:143], a[92:95], v[72:75]
    v_exp_f32 v24, v40
    buffer_load_dwordx4 v18, s[40:43], s65 offen offset:2048 nt lds
    v_mfma_f32_16x16x32_bf16 v[76:79], a[144:147], a[80:83], v[100:103]
    v_exp_f32 v25, v41
    v_mfma_f32_16x16x32_bf16 v[76:79], a[148:151], a[84:87], v[76:79]
    ds_read_b64_tr_b16 a[198:199], v7 offset:4096
    v_cvt_pk_bf16_f32 v131, v30, v31
    v_mfma_f32_16x16x32_bf16 v[76:79], a[152:155], a[88:91], v[76:79]
    v_exp_f32 v26, v42
    v_mfma_f32_16x16x32_bf16 v[76:79], a[156:159], a[92:95], v[76:79]
    v_exp_f32 v27, v43
    buffer_load_dwordx4 v19, s[40:43], s65 offen offset:3072 nt lds
    s_add_u32 s65, s65, 16384
    v_mfma_f32_16x16x32_bf16 v[80:83], a[128:131], a[96:99], v[104:107]
    ds_read_b64_tr_b16 a[200:201], v8 offset:0
    v_cvt_pk_bf16_f32 v132, v24, v25
    v_mfma_f32_16x16x32_bf16 v[80:83], a[132:135], a[100:103], v[80:83]
    v_exp_f32 v28, v44
    v_mfma_f32_16x16x32_bf16 v[80:83], a[136:139], a[104:107], v[80:83]
    v_exp_f32 v29, v45
    v_mfma_f32_16x16x32_bf16 v[80:83], a[140:143], a[108:111], v[80:83]
    ds_read_b64_tr_b16 a[202:203], v8 offset:4096
    v_cvt_pk_bf16_f32 v133, v26, v27
    v_mfma_f32_16x16x32_bf16 v[84:87], a[144:147], a[96:99], v[104:107]
    v_exp_f32 v30, v46
    v_mfma_f32_16x16x32_bf16 v[84:87], a[148:151], a[100:103], v[84:87]
    v_exp_f32 v31, v47
    v_mfma_f32_16x16x32_bf16 v[84:87], a[152:155], a[104:107], v[84:87]
    ds_read_b64_tr_b16 a[204:205], v9 offset:0
    v_cvt_pk_bf16_f32 v134, v28, v29
    v_mfma_f32_16x16x32_bf16 v[84:87], a[156:159], a[108:111], v[84:87]
    v_exp_f32 v24, v48
    v_mfma_f32_16x16x32_bf16 v[88:91], a[128:131], a[112:115], v[108:111]
    v_exp_f32 v25, v49
    v_mfma_f32_16x16x32_bf16 v[88:91], a[132:135], a[116:119], v[88:91]
    ds_read_b64_tr_b16 a[206:207], v9 offset:4096
    v_cvt_pk_bf16_f32 v135, v30, v31
    v_mfma_f32_16x16x32_bf16 v[88:91], a[136:139], a[120:123], v[88:91]
    v_exp_f32 v26, v50
    v_mfma_f32_16x16x32_bf16 v[88:91], a[140:143], a[124:127], v[88:91]
    v_exp_f32 v27, v51
    v_mfma_f32_16x16x32_bf16 v[92:95], a[144:147], a[112:115], v[108:111]
    ds_read_b64_tr_b16 a[208:209], v10 offset:0
    v_cvt_pk_bf16_f32 v136, v24, v25
    v_mfma_f32_16x16x32_bf16 v[92:95], a[148:151], a[116:119], v[92:95]
    v_exp_f32 v28, v52
    v_mfma_f32_16x16x32_bf16 v[92:95], a[152:155], a[120:123], v[92:95]
    v_exp_f32 v29, v53
    v_mfma_f32_16x16x32_bf16 v[92:95], a[156:159], a[124:127], v[92:95]
    ds_read_b64_tr_b16 a[210:211], v10 offset:4096
    v_cvt_pk_bf16_f32 v137, v26, v27
    v_mfma_f32_16x16x32_bf16 v[112:115], v[248:251], v[128:131], 0
    v_exp_f32 v30, v54
    v_mfma_f32_16x16x32_bf16 v[116:119], v[248:251], v[132:135], 0
    v_exp_f32 v31, v55
    ds_read_b64_tr_b16 a[212:213], v11 offset:0
    v_cvt_pk_bf16_f32 v138, v28, v29
    v_exp_f32 v24, v56
    v_exp_f32 v25, v57
    ds_read_b64_tr_b16 a[214:215], v11 offset:4096
    v_cvt_pk_bf16_f32 v139, v30, v31
    v_exp_f32 v26, v58
    v_exp_f32 v27, v59
    v_mfma_f32_16x16x32_bf16 v[120:123], v[248:251], v[136:139], 0
    ds_read_b64_tr_b16 a[216:217], v12 offset:0
    v_cvt_pk_bf16_f32 v140, v24, v25
    v_exp_f32 v28, v60
    v_exp_f32 v29, v61
    ds_read_b64_tr_b16 a[218:219], v12 offset:4096
    v_cvt_pk_bf16_f32 v141, v26, v27
    v_exp_f32 v30, v62
    v_exp_f32 v31, v63
    ds_read_b64_tr_b16 a[220:221], v13 offset:0
    v_cvt_pk_bf16_f32 v142, v28, v29
    ds_read_b64_tr_b16 a[222:223], v13 offset:4096
    v_cvt_pk_bf16_f32 v143, v30, v31
    s_nop 1
    v_mfma_f32_16x16x32_bf16 v[124:127], v[248:251], v[140:143], 0
    s_branch L_it0
.p2align 6
L_it0:
    s_waitcnt vmcnt(8) lgkmcnt(0)
    s_barrier
    v_mfma_f32_16x16x32_bf16 v[160:163], a[192:195], v[128:131], v[160:163]
    v_exp_f32 v24, v64
    v_mfma_f32_16x16x32_bf16 v[192:195], a[192:195], v[132:135], v[192:195]
    s_cmp_eq_u32 s68, 7
    s_cbranch_scc1 L_stubK
L_stubK_back:
    ds_read_b128 a[128:131], v2 offset:16384
    v_mfma_f32_16x16x32_bf16 a[0:3], a[192:195], v[136:139], a[0:3]
    v_exp_f32 v25, v65
    v_mfma_f32_16x16x32_bf16 a[32:35], a[192:195], v[140:143], a[32:35]
    s_add_u32 m0, s66, 0
    v_exp_f32 v26, v66
    v_mfma_f32_16x16x32_bf16 v[164:167], a[196:199], v[128:131], v[164:167]
    buffer_load_dwordx4 v14, s[36:39], s64 offen offset:0 nt lds
    v_mfma_f32_16x16x32_bf16 v[196:199], a[196:199], v[132:135], v[196:199]
    v_exp_f32 v27, v67
    v_mfma_f32_16x16x32_bf16 a[4:7], a[196:199], v[136:139], a[4:7]
    v_exp_f32 v28, v68
    v_mfma_f32_16x16x32_bf16 a[36:39], a[196:199], v[140:143], a[36:39]
    ds_read_b128 a[132:135], v3 offset:16384
    v_add_f32 v20, v20, v112
    v_mfma_f32_16x16x32_bf16 v[168:171], a[200:203], v[128:131], v[168:171]
    v_exp_f32 v29, v69
    v_mfma_f32_16x16x32_bf16 v[200:203], a[200:203], v[132:135], v[200:203]
    ds_read_b128 a[136:139], v4 offset:16384
    v_add_f32 v21, v21, v116
    v_mfma_f32_16x16x32_bf16 a[8:11], a[200:203], v[136:139], a[8:11]
    v_exp_f32 v30, v70
    v_mfma_f32_16x16x32_bf16 a[40:43], a[200:203], v[140:143], a[40:43]
    ds_read_b128 a[140:143], v5 offset:16384
    v_add_f32 v22, v22, v120
    v_mfma_f32_16x16x32_bf16 v[172:175], a[204:207], v[128:131], v[172:175]
    buffer_load_dwordx4 v15, s[36:39], s64 offen offset:1024 nt lds
    v_mfma_f32_16x16x32_bf16 v[204:207], a[204:207], v[132:135], v[204:207]
    v_exp_f32 v31, v71
    v_mfma_f32_16x16x32_bf16 a[12:15], a[204:207], v[136:139], a[12:15]
    ds_read_b128 a[144:147], v2 offset:20480
    v_add_f32 v23, v23, v124
    v_mfma_f32_16x16x32_bf16 a[44:47], a[204:207], v[140:143], a[44:47]
    ds_read_b128 a[148:151], v3 offset:20480
    v_cvt_pk_bf16_f32 v144, v24, v25
    v_mfma_f32_16x16x32_bf16 v[176:179], a[208:211], v[128:131], v[176:179]
    v_exp_f32 v24, v72
    v_mfma_f32_16x16x32_bf16 v[208:211], a[208:211], v[132:135], v[208:211]
    v_exp_f32 v25, v73
    v_mfma_f32_16x16x32_bf16 a[16:19], a[208:211], v[136:139], a[16:19]
    ds_read_b128 a[152:155], v4 offset:20480
    v_cvt_pk_bf16_f32 v145, v26, v27
    v_mfma_f32_16x16x32_bf16 a[48:51], a[208:211], v[140:143], a[48:51]
    v_exp_f32 v26, v74
    v_mfma_f32_16x16x32_bf16 v[180:183], a[212:215], v[128:131], v[180:183]
    buffer_load_dwordx4 v16, s[36:39], s64 offen offset:2048 nt lds
    v_mfma_f32_16x16x32_bf16 v[212:215], a[212:215], v[132:135], v[212:215]
    v_exp_f32 v27, v75
    v_mfma_f32_16x16x32_bf16 a[20:23], a[212:215], v[136:139], a[20:23]
    ds_read_b128 a[156:159], v5 offset:20480
    v_cvt_pk_bf16_f32 v146, v28, v29
    v_mfma_f32_16x16x32_bf16 a[52:55], a[212:215], v[140:143], a[52:55]
    v_exp_f32 v28, v76
    v_mfma_f32_16x16x32_bf16 v[184:187], a[216:219], v[128:131], v[184:187]
    v_exp_f32 v29, v77
    v_mfma_f32_16x16x32_bf16 v[216:219], a[216:219], v[132:135], v[216:219]
    ds_read_b64_tr_b16 a[192:193], v6 offset:8192
    v_cvt_pk_bf16_f32 v147, v30, v31
    v_mfma_f32_16x16x32_bf16 a[24:27], a[216:219], v[136:139], a[24:27]
    v_exp_f32 v30, v78
    v_mfma_f32_16x16x32_bf16 a[56:59], a[216:219], v[140:143], a[56:59]
    v_exp_f32 v31, v79
    v_mfma_f32_16x16x32_bf16 v[112:115], v[248:251], v[144:147], 0
    ds_read_b64_tr_b16 a[194:195], v6 offset:12288
    v_cvt_pk_bf16_f32 v148, v24, v25
    v_mfma_f32_16x16x32_bf16 v[188:191], a[220:223], v[128:131], v[188:191]
    buffer_load_dwordx4 v17, s[36:39], s64 offen offset:3072 nt lds
    v_mfma_f32_16x16x32_bf16 v[220:223], a[220:223], v[132:135], v[220:223]
    s_add_u32 s64, s64, 16384
    v_exp_f32 v24, v80
    v_mfma_f32_16x16x32_bf16 a[28:31], a[220:223], v[136:139], a[28:31]
    v_exp_f32 v25, v81
    v_mfma_f32_16x16x32_bf16 a[60:63], a[220:223], v[140:143], a[60:63]
    ds_read_b64_tr_b16 a[196:197], v7 offset:8192
    v_cvt_pk_bf16_f32 v149, v26, v27
    s_waitcnt lgkmcnt(3)
    v_mfma_f32_16x16x32_bf16 v[32:35], a[128:131], a[64:67], v[96:99]
    v_exp_f32 v26, v82
    v_mfma_f32_16x16x32_bf16 v[32:35], a[132:135], a[68:71], v[32:35]
    v_exp_f32 v27, v83
    v_mfma_f32_16x16x32_bf16 v[32:35], a[136:139], a[72:75], v[32:35]
    ds_read_b64_tr_b16 a[198:199], v7 offset:12288
    v_cvt_pk_bf16_f32 v150, v28, v29
    v_mfma_f32_16x16x32_bf16 v[32:35], a[140:143], a[76:79], v[32:35]
    v_exp_f32 v28, v84
    v_mfma_f32_16x16x32_bf16 v[36:39], a[144:147], a[64:67], v[96:99]
    v_exp_f32 v29, v85
    v_mfma_f32_16x16x32_bf16 v[36:39], a[148:151], a[68:71], v[36:39]
    s_add_u32 m0, s67, 24576
    ds_read_b64_tr_b16 a[200:201], v8 offset:8192
    v_cvt_pk_bf16_f32 v151, v30, v31
    v_mfma_f32_16x16x32_bf16 v[36:39], a[152:155], a[72:75], v[36:39]
    buffer_load_dwordx4 v18, s[40:43], s65 offen offset:0 nt lds
    v_mfma_f32_16x16x32_bf16 v[36:39], a[156:159], a[76:79], v[36:39]
    v_exp_f32 v30, v86
    v_mfma_f32_16x16x32_bf16 v[116:119], v[248:251], v[148:151], 0
    v_exp_f32 v31, v87
    v_mfma_f32_16x16x32_bf16 v[40:43], a[128:131], a[80:83], v[100:103]
    ds_read_b64_tr_b16 a[202:203], v8 offset:12288
    v_cvt_pk_bf16_f32 v152, v24, v25
    v_mfma_f32_16x16x32_bf16 v[40:43], a[132:135], a[84:87], v[40:43]
    v_exp_f32 v24, v88
    v_mfma_f32_16x16x32_bf16 v[40:43], a[136:139], a[88:91], v[40:43]
    v_exp_f32 v25, v89
    v_mfma_f32_16x16x32_bf16 v[40:43], a[140:143], a[92:95], v[40:43]
    ds_read_b64_tr_b16 a[204:205], v9 offset:8192
    v_cvt_pk_bf16_f32 v153, v26, v27
    v_mfma_f32_16x16x32_bf16 v[44:47], a[144:147], a[80:83], v[100:103]
    v_exp_f32 v26, v90
    v_mfma_f32_16x16x32_bf16 v[44:47], a[148:151], a[84:87], v[44:47]
    ds_read_b64_tr_b16 a[206:207], v9 offset:12288
    v_cvt_pk_bf16_f32 v154, v28, v29
    v_mfma_f32_16x16x32_bf16 v[44:47], a[152:155], a[88:91], v[44:47]
    buffer_load_dwordx4 v19, s[40:43], s65 offen offset:1024 nt lds
    v_mfma_f32_16x16x32_bf16 v[44:47], a[156:159], a[92:95], v[44:47]
    v_exp_f32 v27, v91
    v_mfma_f32_16x16x32_bf16 v[48:51], a[128:131], a[96:99], v[104:107]
    v_exp_f32 v28, v92
    v_mfma_f32_16x16x32_bf16 v[48:51], a[132:135], a[100:103], v[48:51]
    v_exp_f32 v29, v93
    v_mfma_f32_16x16x32_bf16 v[48:51], a[136:139], a[104:107], v[48:51]
    ds_read_b64_tr_b16 a[208:209], v10 offset:8192
    v_cvt_pk_bf16_f32 v155, v30, v31
    v_mfma_f32_16x16x32_bf16 v[48:51], a[140:143], a[108:111], v[48:51]
    v_exp_f32 v30, v94
    v_mfma_f32_16x16x32_bf16 v[52:55], a[144:147], a[96:99], v[104:107]
    ds_read_b64_tr_b16 a[210:211], v10 offset:12288
    v_cvt_pk_bf16_f32 v156, v24, v25
    v_mfma_f32_16x16x32_bf16 v[120:123], v[248:251], v[152:155], 0
    ds_read_b64_tr_b16 a[212:213], v11 offset:8192
    v_cvt_pk_bf16_f32 v157, v26, v27
    v_mfma_f32_16x16x32_bf16 v[52:55], a[148:151], a[100:103], v[52:55]
    v_exp_f32 v31, v95
    v_mfma_f32_16x16x32_bf16 v[52:55], a[152:155], a[104:107], v[52:55]
    buffer_load_dwordx4 v18, s[40:43], s65 offen offset:2048 nt lds
    v_mfma_f32_16x16x32_bf16 v[52:55], a[156:159], a[108:111], v[52:55]
    ds_read_b64_tr_b16 a[214:215], v11 offset:12288
    v_cvt_pk_bf16_f32 v158, v28, v29
    v_mfma_f32_16x16x32_bf16 v[56:59], a[128:131], a[112:115], v[108:111]
    ds_read_b64_tr_b16 a[216:217], v12 offset:8192
    v_cvt_pk_bf16_f32 v159, v30, v31
    v_mfma_f32_16x16x32_bf16 v[56:59], a[132:135], a[116:119], v[56:59]
    ds_read_b64_tr_b16 a[218:219], v12 offset:12288
    ds_read_b64_tr_b16 a[220:221], v13 offset:8192
    v_mfma_f32_16x16x32_bf16 v[56:59], a[136:139], a[120:123], v[56:59]
    ds_read_b64_tr_b16 a[222:223], v13 offset:12288
    v_mfma_f32_16x16x32_bf16 v[124:127], v[248:251], v[156:159], 0
    v_mfma_f32_16x16x32_bf16 v[56:59], a[140:143], a[124:127], v[56:59]
    v_mfma_f32_16x16x32_bf16 v[60:63], a[144:147], a[112:115], v[108:111]
    v_mfma_f32_16x16x32_bf16 v[60:63], a[148:151], a[116:119], v[60:63]
    buffer_load_dwordx4 v19, s[40:43], s65 offen offset:3072 nt lds
    v_mfma_f32_16x16x32_bf16 v[60:63], a[152:155], a[120:123], v[60:63]
    s_add_u32 s65, s65, 16384
    v_mfma_f32_16x16x32_bf16 v[60:63], a[156:159], a[124:127], v[60:63]
    s_nop 0
    v_max3_f32 v24, v112, v116, v120
    v_max_f32 v24, v24, v124
    v_cmp_lt_f32 vcc, s69, v24
    s_cbranch_vccnz L_rare0
L_back0:
L_it1:
    s_waitcnt vmcnt(8) lgkmcnt(0)
    s_barrier
    v_mfma_f32_16x16x32_bf16 v[160:163], a[192:195], v[144:147], v[160:163]
    v_exp_f32 v24, v32
    v_mfma_f32_16x16x32_bf16 v[192:195], a[192:195], v[148:151], v[192:195]
    v_exp_f32 v25, v33
    v_mfma_f32_16x16x32_bf16 a[0:3], a[192:195], v[152:155], a[0:3]
    ds_read_b128 a[128:131], v2 offset:24576
    v_add_f32 v20, v20, v112
    v_mfma_f32_16x16x32_bf16 a[32:35], a[192:195], v[156:159], a[32:35]
    s_add_u32 m0, s66, 8192
    v_exp_f32 v26, v34
    v_mfma_f32_16x16x32_bf16 v[164:167], a[196:199], v[144:147], v[164:167]
    buffer_load_dwordx4 v14, s[36:39], s64 offen offset:0 nt lds
    v_mfma_f32_16x16x32_bf16 v[196:199], a[196:199], v[148:151], v[196:199]
    v_exp_f32 v27, v35
    v_mfma_f32_16x16x32_bf16 a[4:7], a[196:199], v[152:155], a[4:7]
    v_exp_f32 v28, v36
    v_mfma_f32_16x16x32_bf16 a[36:39], a[196:199], v[156:159], a[36:39]
    ds_read_b128 a[132:135], v3 offset:24576
    v_add_f32 v21, v21, v116
    v_mfma_f32_16x16x32_bf16 v[168:171], a[200:203], v[144:147], v[168:171]
    v_exp_f32 v29, v37
    v_mfma_f32_16x16x32_bf16 v[200:203], a[200:203], v[148:151], v[200:203]
    ds_read_b128 a[136:139], v4 offset:24576
    v_add_f32 v22, v22, v120
    v_mfma_f32_16x16x32_bf16 a[8:11], a[200:203], v[152:155], a[8:11]
    v_exp_f32 v30, v38
    v_mfma_f32_16x16x32_bf16 a[40:43], a[200:203], v[156:159], a[40:43]
    ds_read_b128 a[140:143], v5 offset:24576
    v_add_f32 v23, v23, v124
    v_mfma_f32_16x16x32_bf16 v[172:175], a[204:207], v[144:147], v[172:175]
    buffer_load_dwordx4 v15, s[36:39], s64 offen offset:1024 nt lds
    v_mfma_f32_16x16x32_bf16 v[204:207], a[204:207], v[148:151], v[204:207]
    v_exp_f32 v31, v39
    v_mfma_f32_16x16x32_bf16 a[12:15], a[204:207], v[152:155], a[12:15]
    ds_read_b128 a[144:147], v2 offset:28672
    v_cvt_pk_bf16_f32 v128, v24, v25
    v_mfma_f32_16x16x32_bf16 a[44:47], a[204:207], v[156:159], a[44:47]
    v_exp_f32 v24, v40
    v_mfma_f32_16x16x32_bf16 v[176:179], a[208:211], v[144:147], v[176:179]
    v_exp_f32 v25, v41
    v_mfma_f32_16x16x32_bf16 v[208:211], a[208:211], v[148:151], v[208:211]
    ds_read_b128 a[148:151], v3 offset:28672
    v_cvt_pk_bf16_f32 v129, v26, v27
    v_mfma_f32_16x16x32_bf16 a[16:19], a[208:211], v[152:155], a[16:19]
    v_exp_f32 v26, v42
    v_mfma_f32_16x16x32_bf16 a[48:51], a[208:211], v[156:159], a[48:51]
    v_exp_f32 v27, v43
    v_mfma_f32_16x16x32_bf16 v[180:183], a[212:215], v[144:147], v[180:183]
    buffer_load_dwordx4 v16, s[36:39], s64 offen offset:2048 nt lds
    v_mfma_f32_16x16x32_bf16 v[212:215], a[212:215], v[148:151], v[212:215]
    ds_read_b128 a[152:155], v4 offset:28672
    v_cvt_pk_bf16_f32 v130, v28, v29
    v_mfma_f32_16x16x32_bf16 a[20:23], a[212:215], v[152:155], a[20:23]
    ds_read_b128 a[156:159], v5 offset:28672
    v_cvt_pk_bf16_f32 v131, v30, v31
    v_mfma_f32_16x16x32_bf16 a[52:55], a[212:215], v[156:159], a[52:55]
    v_exp_f32 v28, v44
    v_mfma_f32_16x16x32_bf16 v[184:187], a[216:219], v[144:147], v[184:187]
    v_exp_f32 v29, v45
    v_mfma_f32_16x16x32_bf16 v[112:115], v[248:251], v[128:131], 0
    v_exp_f32 v30, v46
    v_mfma_f32_16x16x32_bf16 v[216:219], a[216:219], v[148:151], v[216:219]
    v_exp_f32 v31, v47
    v_mfma_f32_16x16x32_bf16 a[24:27], a[216:219], v[152:155], a[24:27]
    ds_read_b64_tr_b16 a[192:193], v6 offset:16384
    v_cvt_pk_bf16_f32 v132, v24, v25
    v_mfma_f32_16x16x32_bf16 a[56:59], a[216:219], v[156:159], a[56:59]
    v_exp_f32 v24, v48
    v_mfma_f32_16x16x32_bf16 v[188:191], a[220:223], v[144:147], v[188:191]
    buffer_load_dwordx4 v17, s[36:39], s64 offen offset:3072 nt lds
    v_mfma_f32_16x16x32_bf16 v[220:223], a[220:223], v[148:151], v[220:223]
    s_add_u32 s64, s64, 16384
    v_exp_f32 v25, v49
    v_mfma_f32_16x16x32_bf16 a[28:31], a[220:223], v[152:155], a[28:31]
    ds_read_b64_tr_b16 a[194:195], v6 offset:20480
    v_cvt_pk_bf16_f32 v133, v26, v27
    v_mfma_f32_16x16x32_bf16 a[60:63], a[220:223], v[156:159], a[60:63]
    v_exp_f32 v26, v50
    s_waitcnt lgkmcnt(2)
    v_mfma_f32_16x16x32_bf16 v[64:67], a[128:131], a[64:67], v[96:99]
    v_exp_f32 v27, v51
    v_mfma_f32_16x16x32_bf16 v[64:67], a[132:135], a[68:71], v[64:67]
    ds_read_b64_tr_b16 a[196:197], v7 offset:16384
    v_cvt_pk_bf16_f32 v134, v28, v29
    v_mfma_f32_16x16x32_bf16 v[64:67], a[136:139], a[72:75], v[64:67]
    v_exp_f32 v28, v52
    v_mfma_f32_16x16x32_bf16 v[64:67], a[140:143], a[76:79], v[64:67]
    s_cmp_eq_u32 s68, 7
    s_cbranch_scc1 L_stubV
L_stubV_back:
    ds_read_b64_tr_b16 a[198:199], v7 offset:20480
    v_mfma_f32_16x16x32_bf16 v[68:71], a[144:147], a[64:67], v[96:99]
    v_exp_f32 v29, v53
    v_mfma_f32_16x16x32_bf16 v[68:71], a[148:151], a[68:71], v[68:71]
    s_add_u32 m0, s67, 0
    ds_read_b64_tr_b16 a[200:201], v8 offset:16384
    v_cvt_pk_bf16_f32 v135, v30, v31
    v_mfma_f32_16x16x32_bf16 v[68:71], a[152:155], a[72:75], v[68:71]
    buffer_load_dwordx4 v18, s[40:43], s65 offen offset:0 nt lds
    v_mfma_f32_16x16x32_bf16 v[68:71], a[156:159], a[76:79], v[68:71]
    v_exp_f32 v30, v54
    v_mfma_f32_16x16x32_bf16 v[116:119], v[248:251], v[132:135], 0
    v_exp_f32 v31, v55
    v_mfma_f32_16x16x32_bf16 v[72:75], a[128:131], a[80:83], v[100:103]
    ds_read_b64_tr_b16 a[202:203], v8 offset:20480
    v_cvt_pk_bf16_f32 v136, v24, v25
    v_mfma_f32_16x16x32_bf16 v[72:75], a[132:135], a[84:87], v[72:75]
    v_exp_f32 v24, v56
    v_mfma_f32_16x16x32_bf16 v[72:75], a[136:139], a[88:91], v[72:75]
    v_exp_f32 v25, v57
    v_mfma_f32_16x16x32_bf16 v[72:75], a[140:143], a[92:95], v[72:75]
    ds_read_b64_tr_b16 a[204:205], v9 offset:16384
    v_cvt_pk_bf16_f32 v137, v26, v27
    v_mfma_f32_16x16x32_bf16 v[76:79], a[144:147], a[80:83], v[100:103]
    v_exp_f32 v26, v58
    v_mfma_f32_16x16x32_bf16 v[76:79], a[148:151], a[84:87], v[76:79]
    ds_read_b64_tr_b16 a[206:207], v9 offset:20480
    v_cvt_pk_bf16_f32 v138, v28, v29
    v_mfma_f32_16x16x32_bf16 v[76:79], a[152:155], a[88:91], v[76:79]
    buffer_load_dwordx4 v19, s[40:43], s65 offen offset:1024 nt lds
    v_mfma_f32_16x16x32_bf16 v[76:79], a[156:159], a[92:95], v[76:79]
    v_exp_f32 v27, v59
    v_mfma_f32_16x16x32_bf16 v[80:83], a[128:131], a[96:99], v[104:107]
    v_exp_f32 v28, v60
    v_mfma_f32_16x16x32_bf16 v[80:83], a[132:135], a[100:103], v[80:83]
    v_exp_f32 v29, v61
    v_mfma_f32_16x16x32_bf16 v[80:83], a[136:139], a[104:107], v[80:83]
    ds_read_b64_tr_b16 a[208:209], v10 offset:16384
    v_cvt_pk_bf16_f32 v139, v30, v31
    v_mfma_f32_16x16x32_bf16 v[80:83], a[140:143], a[108:111], v[80:83]
    v_exp_f32 v30, v62
    v_mfma_f32_16x16x32_bf16 v[84:87], a[144:147], a[96:99], v[104:107]
    ds_read_b64_tr_b16 a[210:211], v10 offset:20480
    v_cvt_pk_bf16_f32 v140, v24, v25
    v_mfma_f32_16x16x32_bf16 v[120:123], v[248:251], v[136:139], 0
    ds_read_b64_tr_b16 a[212:213], v11 offset:16384
    v_cvt_pk_bf16_f32 v141, v26, v27
    v_mfma_f32_16x16x32_bf16 v[84:87], a[148:151], a[100:103], v[84:87]
    v_exp_f32 v31, v63
    v_mfma_f32_16x16x32_bf16 v[84:87], a[152:155], a[104:107], v[84:87]
    buffer_load_dwordx4 v18, s[40:43], s65 offen offset:2048 nt lds
    v_mfma_f32_16x16x32_bf16 v[84:87], a[156:159], a[108:111], v[84:87]
    ds_read_b64_tr_b16 a[214:215], v11 offset:20480
    v_cvt_pk_bf16_f32 v142, v28, v29
    v_mfma_f32_16x16x32_bf16 v[88:91], a[128:131], a[112:115], v[108:111]
    ds_read_b64_tr_b16 a[216:217], v12 offset:16384
    v_cvt_pk_bf16_f32 v143, v30, v31
    v_mfma_f32_16x16x32_bf16 v[88:91], a[132:135], a[116:119], v[88:91]
    ds_read_b64_tr_b16 a[218:219], v12 offset:20480
    ds_read_b64_tr_b16 a[220:221], v13 offset:16384
    v_mfma_f32_16x16x32_bf16 v[88:91], a[136:139], a[120:123], v[88:91]
    ds_read_b64_tr_b16 a[222:223], v13 offset:20480
    v_mfma_f32_16x16x32_bf16 v[124:127], v[248:251], v[140:143], 0
    v_mfma_f32_16x16x32_bf16 v[88:91], a[140:143], a[124:127], v[88:91]
    v_mfma_f32_16x16x32_bf16 v[92:95], a[144:147], a[112:115], v[108:111]
    v_mfma_f32_16x16x32_bf16 v[92:95], a[148:151], a[116:119], v[92:95]
    buffer_load_dwordx4 v19, s[40:43], s65 offen offset:3072 nt lds
    v_mfma_f32_16x16x32_bf16 v[92:95], a[152:155], a[120:123], v[92:95]
    s_add_u32 s65, s65, 16384
    v_mfma_f32_16x16x32_bf16 v[92:95], a[156:159], a[124:127], v[92:95]
    s_nop 0
    v_max3_f32 v24, v112, v116, v120
    v_max_f32 v24, v24, v124
    v_cmp_lt_f32 vcc, s69, v24
    s_cbranch_vccnz L_rare1
L_back1:
L_it2:
    s_waitcnt vmcnt(8) lgkmcnt(0)
    s_barrier
    v_mfma_f32_16x16x32_bf16 v[160:163], a[192:195], v[128:131], v[160:163]
    v_exp_f32 v24, v64
    v_mfma_f32_16x16x32_bf16 v[192:195], a[192:195], v[132:135], v[192:195]
    v_exp_f32 v25, v65
    v_mfma_f32_16x16x32_bf16 a[0:3], a[192:195], v[136:139], a[0:3]
    ds_read_b128 a[128:131], v2 offset:0
    v_add_f32 v20, v20, v112
    v_mfma_f32_16x16x32_bf16 a[32:35], a[192:195], v[140:143], a[32:35]
    s_add_u32 m0, s66, 16384
    v_exp_f32 v26, v66
    v_mfma_f32_16x16x32_bf16 v[164:167], a[196:199], v[128:131], v[164:167]
    buffer_load_dwordx4 v14, s[36:39], s64 offen offset:0 nt lds
    v_mfma_f32_16x16x32_bf16 v[196:199], a[196:199], v[132:135], v[196:199]
    v_exp_f32 v27, v67
    v_mfma_f32_16x16x32_bf16 a[4:7], a[196:199], v[136:139], a[4:7]
    v_exp_f32 v28, v68
    v_mfma_f32_16x16x32_bf16 a[36:39], a[196:199], v[140:143], a[36:39]
    ds_read_b128 a[132:135], v3 offset:0
    v_add_f32 v21, v21, v116
    v_mfma_f32_16x16x32_bf16 v[168:171], a[200:203], v[128:131], v[168:171]
    v_exp_f32 v29, v69
    v_mfma_f32_16x16x32_bf16 v[200:203], a[200:203], v[132:135], v[200:203]
    ds_read_b128 a[136:139], v4 offset:0
    v_add_f32 v22, v22, v120
    v_mfma_f32_16x16x32_bf16 a[8:11], a[200:203], v[136:139], a[8:11]
    v_exp_f32 v30, v70
    v_mfma_f32_16x16x32_bf16 a[40:43], a[200:203], v[140:143], a[40:43]
    ds_read_b128 a[140:143], v5 offset:0
    v_add_f32 v23, v23, v124
    v_mfma_f32_16x16x32_bf16 v[172:175], a[204:207], v[128:131], v[172:175]
    buffer_load_dwordx4 v15, s[36:39], s64 offen offset:1024 nt lds
    v_mfma_f32_16x16x32_bf16 v[204:207], a[204:207], v[132:135], v[204:207]
    v_exp_f32 v31, v71
    v_mfma_f32_16x16x32_bf16 a[12:15], a[204:207], v[136:139], a[12:15]
    ds_read_b128 a[144:147], v2 offset:4096
    v_cvt_pk_bf16_f32 v144, v24, v25
    v_mfma_f32_16x16x32_bf16 a[44:47], a[204:207], v[140:143], a[44:47]
    v_exp_f32 v24, v72
    v_mfma_f32_16x16x32_bf16 v[176:179], a[208:211], v[128:131], v[176:179]
    v_exp_f32 v25, v73
    v_mfma_f32_16x16x32_bf16 v[208:211], a[208:211], v[132:135], v[208:211]
    ds_read_b128 a[148:151], v3 offset:4096
    v_cvt_pk_bf16_f32 v145, v26, v27
    v_mfma_f32_16x16x32_bf16 a[16:19], a[208:211], v[136:139], a[16:19]
    v_exp_f32 v26, v74
    v_mfma_f32_16x16x32_bf16 a[48:51], a[208:211], v[140:143], a[48:51]
    v_exp_f32 v27, v75
    v_mfma_f32_16x16x32_bf16 v[180:183], a[212:215], v[128:131], v[180:183]
    buffer_load_dwordx4 v16, s[36:39], s64 offen offset:2048 nt lds
    v_mfma_f32_16x16x32_bf16 v[212:215], a[212:215], v[132:135], v[212:215]
    ds_read_b128 a[152:155], v4 offset:4096
    v_cvt_pk_bf16_f32 v146, v28, v29
    v_mfma_f32_16x16x32_bf16 a[20:23], a[212:215], v[136:139], a[20:23]
    ds_read_b128 a[156:159], v5 offset:4096
    v_cvt_pk_bf16_f32 v147, v30, v31
    v_mfma_f32_16x16x32_bf16 a[52:55], a[212:215], v[140:143], a[52:55]
    v_exp_f32 v28, v76
    v_mfma_f32_16x16x32_bf16 v[184:187], a[216:219], v[128:131], v[184:187]
    v_exp_f32 v29, v77
    v_mfma_f32_16x16x32_bf16 v[112:115], v[248:251], v[144:147], 0
    v_exp_f32 v30, v78
    v_mfma_f32_16x16x32_bf16 v[216:219], a[216:219], v[132:135], v[216:219]
    v_exp_f32 v31, v79
    v_mfma_f32_16x16x32_bf16 a[24:27], a[216:219], v[136:139], a[24:27]
    ds_read_b64_tr_b16 a[192:193], v6 offset:24576
    v_cvt_pk_bf16_f32 v148, v24, v25
    v_mfma_f32_16x16x32_bf16 a[56:59], a[216:219], v[140:143], a[56:59]
    v_exp_f32 v24, v80
    v_mfma_f32_16x16x32_bf16 v[188:191], a[220:223], v[128:131], v[188:191]
    buffer_load_dwordx4 v17, s[36:39], s64 offen offset:3072 nt lds
    v_mfma_f32_16x16x32_bf16 v[220:223], a[220:223], v[132:135], v[220:223]
    s_add_u32 s64, s64, 16384
    v_exp_f32 v25, v81
    v_mfma_f32_16x16x32_bf16 a[28:31], a[220:223], v[136:139], a[28:31]
    ds_read_b64_tr_b16 a[194:195], v6 offset:28672
    v_cvt_pk_bf16_f32 v149, v26, v27
    v_mfma_f32_16x16x32_bf16 a[60:63], a[220:223], v[140:143], a[60:63]
    v_exp_f32 v26, v82
    s_waitcnt lgkmcnt(2)
    v_mfma_f32_16x16x32_bf16 v[32:35], a[128:131], a[64:67], v[96:99]
    v_exp_f32 v27, v83
    v_mfma_f32_16x16x32_bf16 v[32:35], a[132:135], a[68:71], v[32:35]
    ds_read_b64_tr_b16 a[196:197], v7 offset:24576
    v_cvt_pk_bf16_f32 v150, v28, v29
    v_mfma_f32_16x16x32_bf16 v[32:35], a[136:139], a[72:75], v[32:35]
    v_exp_f32 v28, v84
    v_mfma_f32_16x16x32_bf16 v[32:35], a[140:143], a[76:79], v[32:35]
    ds_read_b64_tr_b16 a[198:199], v7 offset:28672
    v_cvt_pk_bf16_f32 v151, v30, v31
    v_mfma_f32_16x16x32_bf16 v[36:39], a[144:147], a[64:67], v[96:99]
    v_exp_f32 v29, v85
    v_mfma_f32_16x16x32_bf16 v[36:39], a[148:151], a[68:71], v[36:39]
    s_add_u32 m0, s67, 8192
    v_exp_f32 v30, v86
    v_mfma_f32_16x16x32_bf16 v[116:119], v[248:251], v[148:151], 0
    ds_read_b64_tr_b16 a[200:201], v8 offset:24576
    v_cvt_pk_bf16_f32 v152, v24, v25
    v_mfma_f32_16x16x32_bf16 v[36:39], a[152:155], a[72:75], v[36:39]
    buffer_load_dwordx4 v18, s[40:43], s65 offen offset:0 nt lds
    v_mfma_f32_16x16x32_bf16 v[36:39], a[156:159], a[76:79], v[36:39]
    v_exp_f32 v31, v87
    v_mfma_f32_16x16x32_bf16 v[40:43], a[128:131], a[80:83], v[100:103]
    ds_read_b64_tr_b16 a[202:203], v8 offset:28672
    v_cvt_pk_bf16_f32 v153, v26, v27
    v_mfma_f32_16x16x32_bf16 v[40:43], a[132:135], a[84:87], v[40:43]
    v_exp_f32 v24, v88
    v_mfma_f32_16x16x32_bf16 v[40:43], a[136:139], a[88:91], v[40:43]
    v_exp_f32 v25, v89
    v_mfma_f32_16x16x32_bf16 v[40:43], a[140:143], a[92:95], v[40:43]
    ds_read_b64_tr_b16 a[204:205], v9 offset:24576
    v_cvt_pk_bf16_f32 v154, v28, v29
    v_mfma_f32_16x16x32_bf16 v[44:47], a[144:147], a[80:83], v[100:103]
    v_exp_f32 v26, v90
    v_mfma_f32_16x16x32_bf16 v[44:47], a[148:151], a[84:87], v[44:47]
    ds_read_b64_tr_b16 a[206:207], v9 offset:28672
    v_cvt_pk_bf16_f32 v155, v30, v31
    v_mfma_f32_16x16x32_bf16 v[44:47], a[152:155], a[88:91], v[44:47]
    buffer_load_dwordx4 v19, s[40:43], s65 offen offset:1024 nt lds
    v_mfma_f32_16x16x32_bf16 v[44:47], a[156:159], a[92:95], v[44:47]
    v_exp_f32 v27, v91
    v_mfma_f32_16x16x32_bf16 v[120:123], v[248:251], v[152:155], 0
    ds_read_b64_tr_b16 a[208:209], v10 offset:24576
    v_cvt_pk_bf16_f32 v156, v24, v25
    v_mfma_f32_16x16x32_bf16 v[48:51], a[128:131], a[96:99], v[104:107]
    v_exp_f32 v28, v92
    v_mfma_f32_16x16x32_bf16 v[48:51], a[132:135], a[100:103], v[48:51]
    v_exp_f32 v29, v93
    v_mfma_f32_16x16x32_bf16 v[48:51], a[136:139], a[104:107], v[48:51]
    ds_read_b64_tr_b16 a[210:211], v10 offset:28672
    v_cvt_pk_bf16_f32 v157, v26, v27
    v_mfma_f32_16x16x32_bf16 v[48:51], a[140:143], a[108:111], v[48:51]
    v_exp_f32 v30, v94
    v_mfma_f32_16x16x32_bf16 v[52:55], a[144:147], a[96:99], v[104:107]
    ds_read_b64_tr_b16 a[212:213], v11 offset:24576
    v_cvt_pk_bf16_f32 v158, v28, v29
    v_mfma_f32_16x16x32_bf16 v[52:55], a[148:151], a[100:103], v[52:55]
    v_exp_f32 v31, v95
    v_mfma_f32_16x16x32_bf16 v[52:55], a[152:155], a[104:107], v[52:55]
    buffer_load_dwordx4 v18, s[40:43], s65 offen offset:2048 nt lds
    v_mfma_f32_16x16x32_bf16 v[52:55], a[156:159], a[108:111], v[52:55]
    ds_read_b64_tr_b16 a[214:215], v11 offset:28672
    v_cvt_pk_bf16_f32 v159, v30, v31
    v_mfma_f32_16x16x32_bf16 v[56:59], a[128:131], a[112:115], v[108:111]
    ds_read_b64_tr_b16 a[216:217], v12 offset:24576
    ds_read_b64_tr_b16 a[218:219], v12 offset:28672
    v_mfma_f32_16x16x32_bf16 v[56:59], a[132:135], a[116:119], v[56:59]
    ds_read_b64_tr_b16 a[220:221], v13 offset:24576
    ds_read_b64_tr_b16 a[222:223], v13 offset:28672
    v_mfma_f32_16x16x32_bf16 v[124:127], v[248:251], v[156:159], 0
    v_mfma_f32_16x16x32_bf16 v[56:59], a[136:139], a[120:123], v[56:59]
    v_mfma_f32_16x16x32_bf16 v[56:59], a[140:143], a[124:127], v[56:59]
    v_mfma_f32_16x16x32_bf16 v[60:63], a[144:147], a[112:115], v[108:111]
    v_mfma_f32_16x16x32_bf16 v[60:63], a[148:151], a[116:119], v[60:63]
    buffer_load_dwordx4 v19, s[40:43], s65 offen offset:3072 nt lds
    v_mfma_f32_16x16x32_bf16 v[60:63], a[152:155], a[120:123], v[60:63]
    s_add_u32 s65, s65, 16384
    v_mfma_f32_16x16x32_bf16 v[60:63], a[156:159], a[124:127], v[60:63]
    v_max3_f32 v24, v112, v116, v120
    v_max_f32 v24, v24, v124
    v_cmp_lt_f32 vcc, s69, v24
    s_cbranch_vccnz L_rare2
L_back2:
    s_add_u32 s68, s68, 1
    s_cmp_eq_u32 s68, 8
    s_cbranch_scc1 L_epi
L_it3:
    s_waitcnt vmcnt(8) lgkmcnt(0)
    s_barrier
    v_mfma_f32_16x16x32_bf16 v[160:163], a[192:195], v[144:147], v[160:163]
    v_exp_f32 v24, v32
    v_mfma_f32_16x16x32_bf16 v[192:195], a[192:195], v[148:151], v[192:195]
    v_exp_f32 v25, v33
    v_mfma_f32_16x16x32_bf16 a[0:3], a[192:195], v[152:155], a[0:3]
    ds_read_b128 a[128:131], v2 offset:8192
    v_add_f32 v20, v20, v112
    v_mfma_f32_16x16x32_bf16 a[32:35], a[192:195], v[156:159], a[32:35]
    s_add_u32 m0, s66, 24576
    v_exp_f32 v26, v34
    v_mfma_f32_16x16x32_bf16 v[164:167], a[196:199], v[144:147], v[164:167]
    buffer_load_dwordx4 v14, s[36:39], s64 offen offset:0 nt lds
    v_mfma_f32_16x16x32_bf16 v[196:199], a[196:199], v[148:151], v[196:199]
    v_exp_f32 v27, v35
    v_mfma_f32_16x16x32_bf16 a[4:7], a[196:199], v[152:155], a[4:7]
    v_exp_f32 v28, v36
    v_mfma_f32_16x16x32_bf16 a[36:39], a[196:199], v[156:159], a[36:39]
    ds_read_b128 a[132:135], v3 offset:8192
    v_add_f32 v21, v21, v116
    v_mfma_f32_16x16x32_bf16 v[168:171], a[200:203], v[144:147], v[168:171]
    v_exp_f32 v29, v37
    v_mfma_f32_16x16x32_bf16 v[200:203], a[200:203], v[148:151], v[200:203]
    ds_read_b128 a[136:139], v4 offset:8192
    v_add_f32 v22, v22, v120
    v_mfma_f32_16x16x32_bf16 a[8:11], a[200:203], v[152:155], a[8:11]
    v_exp_f32 v30, v38
    v_mfma_f32_16x16x32_bf16 a[40:43], a[200:203], v[156:159], a[40:43]
    ds_read_b128 a[140:143], v5 offset:8192
    v_add_f32 v23, v23, v124
    v_mfma_f32_16x16x32_bf16 v[172:175], a[204:207], v[144:147], v[172:175]
    buffer_load_dwordx4 v15, s[36:39], s64 offen offset:1024 nt lds
    v_mfma_f32_16x16x32_bf16 v[204:207], a[204:207], v[148:151], v[204:207]
    v_exp_f32 v31, v39
    v_mfma_f32_16x16x32_bf16 a[12:15], a[204:207], v[152:155], a[12:15]
    ds_read_b128 a[144:147], v2 offset:12288
    v_cvt_pk_bf16_f32 v128, v24, v25
    v_mfma_f32_16x16x32_bf16 a[44:47], a[204:207], v[156:159], a[44:47]
    v_exp_f32 v24, v40
    v_mfma_f32_16x16x32_bf16 v[176:179], a[208:211], v[144:147], v[176:179]
    v_exp_f32 v25, v41
    v_mfma_f32_16x16x32_bf16 v[208:211], a[208:211], v[148:151], v[208:211]
    ds_read_b128 a[148:151], v3 offset:12288
    v_cvt_pk_bf16_f32 v129, v26, v27
    v_mfma_f32_16x16x32_bf16 a[16:19], a[208:211], v[152:155], a[16:19]
    v_exp_f32 v26, v42
    v_mfma_f32_16x16x32_bf16 a[48:51], a[208:211], v[156:159], a[48:51]
    v_exp_f32 v27, v43
    v_mfma_f32_16x16x32_bf16 v[180:183], a[212:215], v[144:147], v[180:183]
    buffer_load_dwordx4 v16, s[36:39], s64 offen offset:2048 nt lds
    v_mfma_f32_16x16x32_bf16 v[212:215], a[212:215], v[148:151], v[212:215]
    ds_read_b128 a[152:155], v4 offset:12288
    v_cvt_pk_bf16_f32 v130, v28, v29
    v_mfma_f32_16x16x32_bf16 a[20:23], a[212:215], v[152:155], a[20:23]
    ds_read_b128 a[156:159], v5 offset:12288
    v_cvt_pk_bf16_f32 v131, v30, v31
    v_mfma_f32_16x16x32_bf16 a[52:55], a[212:215], v[156:159], a[52:55]
    v_exp_f32 v28, v44
    v_mfma_f32_16x16x32_bf16 v[184:187], a[216:219], v[144:147], v[184:187]
    v_exp_f32 v29, v45
    v_mfma_f32_16x16x32_bf16 v[112:115], v[248:251], v[128:131], 0
    v_exp_f32 v30, v46
    v_mfma_f32_16x16x32_bf16 v[216:219], a[216:219], v[148:151], v[216:219]
    v_exp_f32 v31, v47
    v_mfma_f32_16x16x32_bf16 a[24:27], a[216:219], v[152:155], a[24:27]
    ds_read_b64_tr_b16 a[192:193], v6 offset:0
    v_cvt_pk_bf16_f32 v132, v24, v25
    v_mfma_f32_16x16x32_bf16 a[56:59], a[216:219], v[156:159], a[56:59]
    v_exp_f32 v24, v48
    v_mfma_f32_16x16x32_bf16 v[188:191], a[220:223], v[144:147], v[188:191]
    buffer_load_dwordx4 v17, s[36:39], s64 offen offset:3072 nt lds
    v_mfma_f32_16x16x32_bf16 v[220:223], a[220:223], v[148:151], v[220:223]
    s_add_u32 s64, s64, 16384
    v_exp_f32 v25, v49
    v_mfma_f32_16x16x32_bf16 a[28:31], a[220:223], v[152:155], a[28:31]
    ds_read_b64_tr_b16 a[194:195], v6 offset:4096
    v_cvt_pk_bf16_f32 v133, v26, v27
    v_mfma_f32_16x16x32_bf16 a[60:63], a[220:223], v[156:159], a[60:63]
    v_exp_f32 v26, v50
    s_waitcnt lgkmcnt(2)
    v_mfma_f32_16x16x32_bf16 v[64:67], a[128:131], a[64:67], v[96:99]
    v_exp_f32 v27, v51
    v_mfma_f32_16x16x32_bf16 v[64:67], a[132:135], a[68:71], v[64:67]
    ds_read_b64_tr_b16 a[196:197], v7 offset:0
    v_cvt_pk_bf16_f32 v134, v28, v29
    v_mfma_f32_16x16x32_bf16 v[64:67], a[136:139], a[72:75], v[64:67]
    v_exp_f32 v28, v52
    v_mfma_f32_16x16x32_bf16 v[64:67], a[140:143], a[76:79], v[64:67]
    ds_read_b64_tr_b16 a[198:199], v7 offset:4096
    v_cvt_pk_bf16_f32 v135, v30, v31
    v_mfma_f32_16x16x32_bf16 v[68:71], a[144:147], a[64:67], v[96:99]
    v_exp_f32 v29, v53
    v_mfma_f32_16x16x32_bf16 v[68:71], a[148:151], a[68:71], v[68:71]
    s_add_u32 m0, s67, 16384
    v_exp_f32 v30, v54
    v_mfma_f32_16x16x32_bf16 v[116:119], v[248:251], v[132:135], 0
    ds_read_b64_tr_b16 a[200:201], v8 offset:0
    v_cvt_pk_bf16_f32 v136, v24, v25
    v_mfma_f32_16x16x32_bf16 v[68:71], a[152:155], a[72:75], v[68:71]
    buffer_load_dwordx4 v18, s[40:43], s65 offen offset:0 nt lds
    v_mfma_f32_16x16x32_bf16 v[68:71], a[156:159], a[76:79], v[68:71]
    v_exp_f32 v31, v55
    v_mfma_f32_16x16x32_bf16 v[72:75], a[128:131], a[80:83], v[100:103]
    ds_read_b64_tr_b16 a[202:203], v8 offset:4096
    v_cvt_pk_bf16_f32 v137, v26, v27
    v_mfma_f32_16x16x32_bf16 v[72:75], a[132:135], a[84:87], v[72:75]
    v_exp_f32 v24, v56
    v_mfma_f32_16x16x32_bf16 v[72:75], a[136:139], a[88:91], v[72:75]
    v_exp_f32 v25, v57
    v_mfma_f32_16x16x32_bf16 v[72:75], a[140:143], a[92:95], v[72:75]
    ds_read_b64_tr_b16 a[204:205], v9 offset:0
    v_cvt_pk_bf16_f32 v138, v28, v29
    v_mfma_f32_16x16x32_bf16 v[76:79], a[144:147], a[80:83], v[100:103]
    v_exp_f32 v26, v58
    v_mfma_f32_16x16x32_bf16 v[76:79], a[148:151], a[84:87], v[76:79]
    ds_read_b64_tr_b16 a[206:207], v9 offset:4096
    v_cvt_pk_bf16_f32 v139, v30, v31
    v_mfma_f32_16x16x32_bf16 v[76:79], a[152:155], a[88:91], v[76:79]
    buffer_load_dwordx4 v19, s[40:43], s65 offen offset:1024 nt lds
    v_mfma_f32_16x16x32_bf16 v[76:79], a[156:159], a[92:95], v[76:79]
    v_exp_f32 v27, v59
    v_mfma_f32_16x16x32_bf16 v[120:123], v[248:251], v[136:139], 0
    ds_read_b64_tr_b16 a[208:209], v10 offset:0
    v_cvt_pk_bf16_f32 v140, v24, v25
    v_mfma_f32_16x16x32_bf16 v[80:83], a[128:131], a[96:99], v[104:107]
    v_exp_f32 v28, v60
    v_mfma_f32_16x16x32_bf16 v[80:83], a[132:135], a[100:103], v[80:83]
    v_exp_f32 v29, v61
    v_mfma_f32_16x16x32_bf16 v[80:83], a[136:139], a[104:107], v[80:83]
    ds_read_b64_tr_b16 a[210:211], v10 offset:4096
    v_cvt_pk_bf16_f32 v141, v26, v27
    v_mfma_f32_16x16x32_bf16 v[80:83], a[140:143], a[108:111], v[80:83]
    v_exp_f32 v30, v62
    v_mfma_f32_16x16x32_bf16 v[84:87], a[144:147], a[96:99], v[104:107]
    ds_read_b64_tr_b16 a[212:213], v11 offset:0
    v_cvt_pk_bf16_f32 v142, v28, v29
    v_mfma_f32_16x16x32_bf16 v[84:87], a[148:151], a[100:103], v[84:87]
    v_exp_f32 v31, v63
    v_mfma_f32_16x16x32_bf16 v[84:87], a[152:155], a[104:107], v[84:87]
    buffer_load_dwordx4 v18, s[40:43], s65 offen offset:2048 nt lds
    v_mfma_f32_16x16x32_bf16 v[84:87], a[156:159], a[108:111], v[84:87]
    ds_read_b64_tr_b16 a[214:215], v11 offset:4096
    v_cvt_pk_bf16_f32 v143, v30, v31
    v_mfma_f32_16x16x32_bf16 v[88:91], a[128:131], a[112:115], v[108:111]
    ds_read_b64_tr_b16 a[216:217], v12 offset:0
    ds_read_b64_tr_b16 a[218:219], v12 offset:4096
    v_mfma_f32_16x16x32_bf16 v[88:91], a[132:135], a[116:119], v[88:91]
    ds_read_b64_tr_b16 a[220:221], v13 offset:0
    ds_read_b64_tr_b16 a[222:223], v13 offset:4096
    v_mfma_f32_16x16x32_bf16 v[124:127], v[248:251], v[140:143], 0
    v_mfma_f32_16x16x32_bf16 v[88:91], a[136:139], a[120:123], v[88:91]
    v_mfma_f32_16x16x32_bf16 v[88:91], a[140:143], a[124:127], v[88:91]
    v_mfma_f32_16x16x32_bf16 v[92:95], a[144:147], a[112:115], v[108:111]
    v_mfma_f32_16x16x32_bf16 v[92:95], a[148:151], a[116:119], v[92:95]
    buffer_load_dwordx4 v19, s[40:43], s65 offen offset:3072 nt lds
    v_mfma_f32_16x16x32_bf16 v[92:95], a[152:155], a[120:123], v[92:95]
    s_add_u32 s65, s65, 16384
    v_mfma_f32_16x16x32_bf16 v[92:95], a[156:159], a[124:127], v[92:95]
    v_max3_f32 v24, v112, v116, v120
    v_max_f32 v24, v24, v124
    v_cmp_lt_f32 vcc, s69, v24
    s_cbranch_vccnz L_rare3
L_back3:
    s_branch L_it0
L_epi:
    s_waitcnt vmcnt(0) lgkmcnt(0)
    s_barrier
    v_mfma_f32_16x16x32_bf16 a[0:3], a[192:195], v[152:155], a[0:3]
    ds_read_b64_tr_b16 a[128:129], v6 offset:0
    v_add_f32 v32, v32, v224
    v_add_f32 v33, v33, v225
    v_mfma_f32_16x16x32_bf16 a[4:7], a[196:199], v[152:155], a[4:7]
    ds_read_b64_tr_b16 a[130:131], v6 offset:4096
    v_add_f32 v34, v34, v226
    v_add_f32 v35, v35, v227
    v_mfma_f32_16x16x32_bf16 a[8:11], a[200:203], v[152:155], a[8:11]
    ds_read_b64_tr_b16 a[132:133], v7 offset:0
    v_add_f32 v36, v36, v228
    v_add_f32 v37, v37, v229
    v_mfma_f32_16x16x32_bf16 a[12:15], a[204:207], v[152:155], a[12:15]
    ds_read_b64_tr_b16 a[134:135], v7 offset:4096
    v_add_f32 v38, v38, v230
    v_add_f32 v39, v39, v231
    v_mfma_f32_16x16x32_bf16 a[16:19], a[208:211], v[152:155], a[16:19]
    ds_read_b64_tr_b16 a[136:137], v8 offset:0
    v_exp_f32 v24, v32
    v_mfma_f32_16x16x32_bf16 a[20:23], a[212:215], v[152:155], a[20:23]
    ds_read_b64_tr_b16 a[138:139], v8 offset:4096
    v_exp_f32 v25, v33
    v_mfma_f32_16x16x32_bf16 a[24:27], a[216:219], v[152:155], a[24:27]
    ds_read_b64_tr_b16 a[140:141], v9 offset:0
    v_add_f32 v40, v40, v232
    v_add_f32 v41, v41, v233
    v_mfma_f32_16x16x32_bf16 a[28:31], a[220:223], v[152:155], a[28:31]
    ds_read_b64_tr_b16 a[142:143], v9 offset:4096
    v_add_f32 v42, v42, v234
    v_add_f32 v43, v43, v235
    v_mfma_f32_16x16x32_bf16 a[32:35], a[192:195], v[156:159], a[32:35]
    ds_read_b64_tr_b16 a[144:145], v10 offset:0
    v_add_f32 v44, v44, v236
    v_add_f32 v45, v45, v237
    v_mfma_f32_16x16x32_bf16 a[36:39], a[196:199], v[156:159], a[36:39]
    ds_read_b64_tr_b16 a[146:147], v10 offset:4096
    v_add_f32 v46, v46, v238
    v_add_f32 v47, v47, v239
    v_mfma_f32_16x16x32_bf16 a[40:43], a[200:203], v[156:159], a[40:43]
    ds_read_b64_tr_b16 a[148:149], v11 offset:0
    v_add_f32 v20, v20, v112
    v_add_f32 v21, v21, v116
    v_mfma_f32_16x16x32_bf16 a[44:47], a[204:207], v[156:159], a[44:47]
    ds_read_b64_tr_b16 a[150:151], v11 offset:4096
    v_add_f32 v22, v22, v120
    v_add_f32 v23, v23, v124
    v_mfma_f32_16x16x32_bf16 a[48:51], a[208:211], v[156:159], a[48:51]
    ds_read_b64_tr_b16 a[152:153], v12 offset:0
    s_lshl_b32 s6, s3, 14
    v_lshlrev_b32 v247, 4, v0
    v_mfma_f32_16x16x32_bf16 a[52:55], a[212:215], v[156:159], a[52:55]
    ds_read_b64_tr_b16 a[154:155], v12 offset:4096
    v_add_u32 v60, s6, v247
    v_exp_f32 v26, v34
    v_mfma_f32_16x16x32_bf16 a[56:59], a[216:219], v[156:159], a[56:59]
    ds_read_b64_tr_b16 a[156:157], v13 offset:0
    v_exp_f32 v27, v35
    v_mfma_f32_16x16x32_bf16 a[60:63], a[220:223], v[156:159], a[60:63]
    ds_read_b64_tr_b16 a[158:159], v13 offset:4096
    v_cvt_pk_bf16_f32 v128, v24, v25
    v_exp_f32 v28, v36
    v_mfma_f32_16x16x32_bf16 v[160:163], a[192:195], v[144:147], v[160:163]
    ds_write_b128 v60, a[0:3] offset:0
    v_exp_f32 v29, v37
    v_mfma_f32_16x16x32_bf16 v[164:167], a[196:199], v[144:147], v[164:167]
    v_cvt_pk_bf16_f32 v129, v26, v27
    v_exp_f32 v30, v38
    v_mfma_f32_16x16x32_bf16 v[168:171], a[200:203], v[144:147], v[168:171]
    ds_write_b128 v60, a[4:7] offset:1024
    v_exp_f32 v31, v39
    v_mfma_f32_16x16x32_bf16 v[172:175], a[204:207], v[144:147], v[172:175]
    v_cvt_pk_bf16_f32 v130, v28, v29
    v_exp_f32 v24, v40
    v_mfma_f32_16x16x32_bf16 v[176:179], a[208:211], v[144:147], v[176:179]
    ds_write_b128 v60, a[8:11] offset:2048
    v_exp_f32 v25, v41
    v_mfma_f32_16x16x32_bf16 v[180:183], a[212:215], v[144:147], v[180:183]
    v_cvt_pk_bf16_f32 v131, v30, v31
    v_exp_f32 v26, v42
    v_mfma_f32_16x16x32_bf16 v[184:187], a[216:219], v[144:147], v[184:187]
    ds_write_b128 v60, a[12:15] offset:3072
    v_exp_f32 v27, v43
    v_mfma_f32_16x16x32_bf16 v[188:191], a[220:223], v[144:147], v[188:191]
    v_cvt_pk_bf16_f32 v132, v24, v25
    v_exp_f32 v28, v44
    v_mfma_f32_16x16x32_bf16 v[192:195], a[192:195], v[148:151], v[192:195]
    ds_write_b128 v60, a[16:19] offset:4096
    v_exp_f32 v29, v45
    v_mfma_f32_16x16x32_bf16 v[196:199], a[196:199], v[148:151], v[196:199]
    v_cvt_pk_bf16_f32 v133, v26, v27
    v_exp_f32 v30, v46
    v_mfma_f32_16x16x32_bf16 v[200:203], a[200:203], v[148:151], v[200:203]
    ds_write_b128 v60, a[20:23] offset:5120
    v_exp_f32 v31, v47
    v_mfma_f32_16x16x32_bf16 v[204:207], a[204:207], v[148:151], v[204:207]
    v_cvt_pk_bf16_f32 v134, v28, v29
    v_cvt_pk_bf16_f32 v135, v30, v31
    v_mfma_f32_16x16x32_bf16 v[208:211], a[208:211], v[148:151], v[208:211]
    ds_write_b128 v60, a[24:27] offset:6144
    v_mfma_f32_16x16x32_bf16 v[212:215], a[212:215], v[148:151], v[212:215]
    v_mfma_f32_16x16x32_bf16 v[216:219], a[216:219], v[148:151], v[216:219]
    ds_write_b128 v60, a[28:31] offset:7168
    v_mfma_f32_16x16x32_bf16 v[220:223], a[220:223], v[148:151], v[220:223]
    s_nop 1
    v_mfma_f32_16x16x32_bf16 v[112:115], v[248:251], v[128:131], 0
    v_mfma_f32_16x16x32_bf16 v[116:119], v[248:251], v[132:135], 0
    v_xor_b32 v61, 0x8000, v60
    s_lshl_b32 s6, s3, 10
    s_add_u32 s6, s6, 131072
    v_add_u32 v62, s6, v247
    v_xor_b32 v63, 0x800, v62
    v_mov_b32 v240, v104
    v_mov_b32 v241, v108
    v_mov_b32 v242, v22
    v_mov_b32 v243, v23
    ds_write_b128 v62, v[240:243]
    v_max_f32 v24, v112, v116
    v_cmp_lt_f32 vcc, s69, v24
    s_waitcnt lgkmcnt(4)
    s_cbranch_vccnz L_rareT
L_backT:
    v_mfma_f32_16x16x32_bf16 v[160:163], a[128:131], v[128:131], v[160:163]
    ds_write_b128 v60, a[32:35] offset:8192
    v_add_f32 v20, v20, v112
    v_add_f32 v21, v21, v116
    v_mfma_f32_16x16x32_bf16 v[164:167], a[132:135], v[128:131], v[164:167]
    ds_write_b128 v60, a[36:39] offset:9216
    s_lshl_b32 s6, s3, 13
    s_add_u32 s6, s6, 65536
    v_mfma_f32_16x16x32_bf16 v[168:171], a[136:139], v[128:131], v[168:171]
    ds_write_b128 v60, a[40:43] offset:10240
    v_and_b32 v24, 15, v0
    v_lshrrev_b32 v25, 5, v0
    v_mfma_f32_16x16x32_bf16 v[172:175], a[140:143], v[128:131], v[172:175]
    ds_write_b128 v60, a[44:47] offset:11264
    v_xor_b32 v25, v25, v24
    v_lshlrev_b32 v26, 8, v24
    v_mfma_f32_16x16x32_bf16 v[176:179], a[144:147], v[128:131], v[176:179]
    ds_write_b128 v60, a[48:51] offset:12288
    v_lshl_or_b32 v25, v25, 4, v26
    v_bfe_u32 v26, v0, 4, 1
    v_mfma_f32_16x16x32_bf16 v[180:183], a[148:151], v[128:131], v[180:183]
    ds_write_b128 v60, a[52:55] offset:13312
    v_lshl_or_b32 v25, v26, 3, v25
    v_add_u32 v48, s6, v25
    v_mfma_f32_16x16x32_bf16 v[184:187], a[152:155], v[128:131], v[184:187]
    ds_write_b128 v60, a[56:59] offset:14336
    v_xor_b32 v49, 32, v48
    v_xor_b32 v50, 64, v48
    v_mfma_f32_16x16x32_bf16 v[188:191], a[156:159], v[128:131], v[188:191]
    ds_write_b128 v60, a[60:63] offset:15360
    v_xor_b32 v51, 96, v48
    v_xor_b32 v52, 128, v48
    v_mfma_f32_16x16x32_bf16 v[192:195], a[128:131], v[132:135], v[192:195]
    v_xor_b32 v53, 160, v48
    v_xor_b32 v54, 192, v48
    v_mfma_f32_16x16x32_bf16 v[196:199], a[132:135], v[132:135], v[196:199]
    v_xor_b32 v55, 224, v48
    v_add_u32 v56, s6, v14
    v_mfma_f32_16x16x32_bf16 v[200:203], a[136:139], v[132:135], v[200:203]
    v_add_u32 v57, s6, v15
    v_add_u32 v58, s6, v16
    v_mfma_f32_16x16x32_bf16 v[204:207], a[140:143], v[132:135], v[204:207]
    v_add_u32 v59, s6, v17
    s_add_u32 s7, s71, 4096
    v_mfma_f32_16x16x32_bf16 v[208:211], a[144:147], v[132:135], v[208:211]
    v_mfma_f32_16x16x32_bf16 v[212:215], a[148:151], v[132:135], v[212:215]
    v_mfma_f32_16x16x32_bf16 v[216:219], a[152:155], v[132:135], v[216:219]
    v_mfma_f32_16x16x32_bf16 v[220:223], a[156:159], v[132:135], v[220:223]
    s_waitcnt lgkmcnt(0)
    s_barrier
    ds_read_b128 v[228:231], v63
    v_mov_b32 v232, v96
    v_mov_b32 v233, v100
    ds_read_b128 v[64:67], v61 offset:0
    ds_read_b128 v[68:71], v61 offset:1024
    ds_read_b128 v[72:75], v61 offset:2048
    ds_read_b128 v[76:79], v61 offset:3072
    ds_read_b128 v[80:83], v61 offset:4096
    ds_read_b128 v[84:87], v61 offset:5120
    ds_read_b128 v[88:91], v61 offset:6144
    ds_read_b128 v[92:95], v61 offset:7168
    ds_read_b128 v[96:99], v61 offset:8192
    ds_read_b128 v[100:103], v61 offset:9216
    ds_read_b128 v[104:107], v61 offset:10240
    ds_read_b128 v[108:111], v61 offset:11264
    ds_read_b128 v[112:115], v61 offset:12288
    ds_read_b128 v[116:119], v61 offset:13312
    s_waitcnt lgkmcnt(14)
    ds_read_b128 v[120:123], v61 offset:14336
    ds_read_b128 v[124:127], v61 offset:15360
    v_min_f32 v24, v232, v228
    v_sub_f32 v236, v24, v232
    v_sub_f32 v240, v24, v228
    v_min_f32 v25, v233, v229
    v_sub_f32 v238, v25, v233
    v_sub_f32 v242, v25, v229
    v_exp_f32 v236, v236
    v_exp_f32 v240, v240
    v_exp_f32 v238, v238
    v_exp_f32 v242, v242
    v_mul_f32 v24, v20, v236
    v_mul_f32 v25, v21, v238
    v_fma_f32 v24, v230, v240, v24
    v_fma_f32 v25, v231, v242, v25
    v_rcp_f32 v24, v24
    v_rcp_f32 v25, v25
    s_nop 0
    v_mul_f32 v236, v236, v24
    v_mul_f32 v240, v240, v24
    v_mul_f32 v238, v238, v25
    v_mul_f32 v242, v242, v25
    v_pk_mul_f32 v[160:161], v[160:161], v[236:237] op_sel_hi:[1,0]
    v_pk_mul_f32 v[162:163], v[162:163], v[236:237] op_sel_hi:[1,0]
    s_waitcnt lgkmcnt(15)
    v_pk_fma_f32 v[160:161], v[64:65], v[240:241], v[160:161] op_sel_hi:[1,0,1]
    v_pk_fma_f32 v[162:163], v[66:67], v[240:241], v[162:163] op_sel_hi:[1,0,1]
    v_cvt_pk_bf16_f32 v128, v160, v161
    v_cvt_pk_bf16_f32 v129, v162, v163
    ds_write_b64 v48, v[128:129] offset:0
    v_pk_mul_f32 v[164:165], v[164:165], v[236:237] op_sel_hi:[1,0]
    v_pk_mul_f32 v[166:167], v[166:167], v[236:237] op_sel_hi:[1,0]
    s_waitcnt lgkmcnt(15)
    v_pk_fma_f32 v[164:165], v[68:69], v[240:241], v[164:165] op_sel_hi:[1,0,1]
    v_pk_fma_f32 v[166:167], v[70:71], v[240:241], v[166:167] op_sel_hi:[1,0,1]
    v_cvt_pk_bf16_f32 v130, v164, v165
    v_cvt_pk_bf16_f32 v131, v166, v167
    ds_write_b64 v49, v[130:131] offset:0
    v_pk_mul_f32 v[168:169], v[168:169], v[236:237] op_sel_hi:[1,0]
    v_pk_mul_f32 v[170:171], v[170:171], v[236:237] op_sel_hi:[1,0]
    s_waitcnt lgkmcnt(15)
    v_pk_fma_f32 v[168:169], v[72:73], v[240:241], v[168:169] op_sel_hi:[1,0,1]
    v_pk_fma_f32 v[170:171], v[74:75], v[240:241], v[170:171] op_sel_hi:[1,0,1]
    v_cvt_pk_bf16_f32 v132, v168, v169
    v_cvt_pk_bf16_f32 v133, v170, v171
    ds_write_b64 v50, v[132:133] offset:0
    v_pk_mul_f32 v[172:173], v[172:173], v[236:237] op_sel_hi:[1,0]
    v_pk_mul_f32 v[174:175], v[174:175], v[236:237] op_sel_hi:[1,0]
    s_waitcnt lgkmcnt(15)
    v_pk_fma_f32 v[172:173], v[76:77], v[240:241], v[172:173] op_sel_hi:[1,0,1]
    v_pk_fma_f32 v[174:175], v[78:79], v[240:241], v[174:175] op_sel_hi:[1,0,1]
    v_cvt_pk_bf16_f32 v134, v172, v173
    v_cvt_pk_bf16_f32 v135, v174, v175
    ds_write_b64 v51, v[134:135] offset:0
    v_pk_mul_f32 v[176:177], v[176:177], v[236:237] op_sel_hi:[1,0]
    v_pk_mul_f32 v[178:179], v[178:179], v[236:237] op_sel_hi:[1,0]
    s_waitcnt lgkmcnt(15)
    v_pk_fma_f32 v[176:177], v[80:81], v[240:241], v[176:177] op_sel_hi:[1,0,1]
    v_pk_fma_f32 v[178:179], v[82:83], v[240:241], v[178:179] op_sel_hi:[1,0,1]
    v_cvt_pk_bf16_f32 v136, v176, v177
    v_cvt_pk_bf16_f32 v137, v178, v179
    ds_write_b64 v52, v[136:137] offset:0
    v_pk_mul_f32 v[180:181], v[180:181], v[236:237] op_sel_hi:[1,0]
    v_pk_mul_f32 v[182:183], v[182:183], v[236:237] op_sel_hi:[1,0]
    s_waitcnt lgkmcnt(15)
    v_pk_fma_f32 v[180:181], v[84:85], v[240:241], v[180:181] op_sel_hi:[1,0,1]
    v_pk_fma_f32 v[182:183], v[86:87], v[240:241], v[182:183] op_sel_hi:[1,0,1]
    v_cvt_pk_bf16_f32 v138, v180, v181
    v_cvt_pk_bf16_f32 v139, v182, v183
    ds_write_b64 v53, v[138:139] offset:0
    v_pk_mul_f32 v[184:185], v[184:185], v[236:237] op_sel_hi:[1,0]
    v_pk_mul_f32 v[186:187], v[186:187], v[236:237] op_sel_hi:[1,0]
    s_waitcnt lgkmcnt(15)
    v_pk_fma_f32 v[184:185], v[88:89], v[240:241], v[184:185] op_sel_hi:[1,0,1]
    v_pk_fma_f32 v[186:187], v[90:91], v[240:241], v[186:187] op_sel_hi:[1,0,1]
    v_cvt_pk_bf16_f32 v140, v184, v185
    v_cvt_pk_bf16_f32 v141, v186, v187
    ds_write_b64 v54, v[140:141] offset:0
    v_pk_mul_f32 v[188:189], v[188:189], v[236:237] op_sel_hi:[1,0]
    v_pk_mul_f32 v[190:191], v[190:191], v[236:237] op_sel_hi:[1,0]
    s_waitcnt lgkmcnt(15)
    v_pk_fma_f32 v[188:189], v[92:93], v[240:241], v[188:189] op_sel_hi:[1,0,1]
    v_pk_fma_f32 v[190:191], v[94:95], v[240:241], v[190:191] op_sel_hi:[1,0,1]
    v_cvt_pk_bf16_f32 v142, v188, v189
    v_cvt_pk_bf16_f32 v143, v190, v191
    ds_write_b64 v55, v[142:143] offset:0
    v_pk_mul_f32 v[192:193], v[192:193], v[238:239] op_sel_hi:[1,0]
    v_pk_mul_f32 v[194:195], v[194:195], v[238:239] op_sel_hi:[1,0]
    s_waitcnt lgkmcnt(15)
    v_pk_fma_f32 v[192:193], v[96:97], v[242:243], v[192:193] op_sel_hi:[1,0,1]
    v_pk_fma_f32 v[194:195], v[98:99], v[242:243], v[194:195] op_sel_hi:[1,0,1]
    v_cvt_pk_bf16_f32 v144, v192, v193
    v_cvt_pk_bf16_f32 v145, v194, v195
    ds_write_b64 v48, v[144:145] offset:4096
    v_pk_mul_f32 v[196:197], v[196:197], v[238:239] op_sel_hi:[1,0]
    v_pk_mul_f32 v[198:199], v[198:199], v[238:239] op_sel_hi:[1,0]
    s_waitcnt lgkmcnt(15)
    v_pk_fma_f32 v[196:197], v[100:101], v[242:243], v[196:197] op_sel_hi:[1,0,1]
    v_pk_fma_f32 v[198:199], v[102:103], v[242:243], v[198:199] op_sel_hi:[1,0,1]
    v_cvt_pk_bf16_f32 v146, v196, v197
    v_cvt_pk_bf16_f32 v147, v198, v199
    ds_write_b64 v49, v[146:147] offset:4096
    ds_read_b128 v[160:163], v56 offset:0
    ds_read_b128 v[164:167], v57 offset:1024
    ds_read_b128 v[168:171], v58 offset:2048
    ds_read_b128 v[172:175], v59 offset:3072
    v_pk_mul_f32 v[200:201], v[200:201], v[238:239] op_sel_hi:[1,0]
    v_pk_mul_f32 v[202:203], v[202:203], v[238:239] op_sel_hi:[1,0]
    s_waitcnt lgkmcnt(15)
    v_pk_fma_f32 v[200:201], v[104:105], v[242:243], v[200:201] op_sel_hi:[1,0,1]
    v_pk_fma_f32 v[202:203], v[106:107], v[242:243], v[202:203] op_sel_hi:[1,0,1]
    v_cvt_pk_bf16_f32 v148, v200, v201
    v_cvt_pk_bf16_f32 v149, v202, v203
    ds_write_b64 v50, v[148:149] offset:4096
    v_pk_mul_f32 v[204:205], v[204:205], v[238:239] op_sel_hi:[1,0]
    v_pk_mul_f32 v[206:207], v[206:207], v[238:239] op_sel_hi:[1,0]
    s_waitcnt lgkmcnt(15)
    v_pk_fma_f32 v[204:205], v[108:109], v[242:243], v[204:205] op_sel_hi:[1,0,1]
    v_pk_fma_f32 v[206:207], v[110:111], v[242:243], v[206:207] op_sel_hi:[1,0,1]
    v_cvt_pk_bf16_f32 v150, v204, v205
    v_cvt_pk_bf16_f32 v151, v206, v207
    ds_write_b64 v51, v[150:151] offset:4096
    v_pk_mul_f32 v[208:209], v[208:209], v[238:239] op_sel_hi:[1,0]
    v_pk_mul_f32 v[210:211], v[210:211], v[238:239] op_sel_hi:[1,0]
    s_waitcnt lgkmcnt(15)
    v_pk_fma_f32 v[208:209], v[112:113], v[242:243], v[208:209] op_sel_hi:[1,0,1]
    v_pk_fma_f32 v[210:211], v[114:115], v[242:243], v[210:211] op_sel_hi:[1,0,1]
    v_cvt_pk_bf16_f32 v152, v208, v209
    v_cvt_pk_bf16_f32 v153, v210, v211
    ds_write_b64 v52, v[152:153] offset:4096
    s_waitcnt lgkmcnt(6)
    buffer_store_dwordx4 v[160:163], v247, s[60:63], s71 offen offset:0 nt
    v_pk_mul_f32 v[212:213], v[212:213], v[238:239] op_sel_hi:[1,0]
    v_pk_mul_f32 v[214:215], v[214:215], v[238:239] op_sel_hi:[1,0]
    v_pk_fma_f32 v[212:213], v[116:117], v[242:243], v[212:213] op_sel_hi:[1,0,1]
    v_pk_fma_f32 v[214:215], v[118:119], v[242:243], v[214:215] op_sel_hi:[1,0,1]
    v_cvt_pk_bf16_f32 v154, v212, v213
    v_cvt_pk_bf16_f32 v155, v214, v215
    ds_write_b64 v53, v[154:155] offset:4096
    s_waitcnt lgkmcnt(6)
    buffer_store_dwordx4 v[164:167], v247, s[60:63], s71 offen offset:1024 nt
    v_pk_mul_f32 v[216:217], v[216:217], v[238:239] op_sel_hi:[1,0]
    v_pk_mul_f32 v[218:219], v[218:219], v[238:239] op_sel_hi:[1,0]
    v_pk_fma_f32 v[216:217], v[120:121], v[242:243], v[216:217] op_sel_hi:[1,0,1]
    v_pk_fma_f32 v[218:219], v[122:123], v[242:243], v[218:219] op_sel_hi:[1,0,1]
    v_cvt_pk_bf16_f32 v156, v216, v217
    v_cvt_pk_bf16_f32 v157, v218, v219
    ds_write_b64 v54, v[156:157] offset:4096
    s_waitcnt lgkmcnt(6)
    buffer_store_dwordx4 v[168:171], v247, s[60:63], s71 offen offset:2048 nt
    v_pk_mul_f32 v[220:221], v[220:221], v[238:239] op_sel_hi:[1,0]
    v_pk_mul_f32 v[222:223], v[222:223], v[238:239] op_sel_hi:[1,0]
    v_pk_fma_f32 v[220:221], v[124:125], v[242:243], v[220:221] op_sel_hi:[1,0,1]
    v_pk_fma_f32 v[222:223], v[126:127], v[242:243], v[222:223] op_sel_hi:[1,0,1]
    v_cvt_pk_bf16_f32 v158, v220, v221
    v_cvt_pk_bf16_f32 v159, v222, v223
    ds_write_b64 v55, v[158:159] offset:4096
    s_waitcnt lgkmcnt(6)
    buffer_store_dwordx4 v[172:175], v247, s[60:63], s71 offen offset:3072 nt
    ds_read_b128 v[176:179], v56 offset:4096
    ds_read_b128 v[180:183], v57 offset:5120
    ds_read_b128 v[184:187], v58 offset:6144
    ds_read_b128 v[188:191], v59 offset:7168
    s_waitcnt lgkmcnt(3)
    buffer_store_dwordx4 v[176:179], v247, s[60:63], s7 offen offset:0 nt
    s_waitcnt lgkmcnt(2)
    buffer_store_dwordx4 v[180:183], v247, s[60:63], s7 offen offset:1024 nt
    s_waitcnt lgkmcnt(1)
    buffer_store_dwordx4 v[184:187], v247, s[60:63], s7 offen offset:2048 nt
    s_waitcnt lgkmcnt(0)
    buffer_store_dwordx4 v[188:191], v247, s[60:63], s7 offen offset:3072 nt
L_end:
    s_endpgm
L_stubK:
    s_mov_b32 s36, s48
    s_mov_b32 s37, s49
    s_mov_b32 s38, s50
    s_mov_b32 s64, s74
    s_branch L_stubK_back
L_stubV:
    s_mov_b32 s40, s52
    s_mov_b32 s41, s53
    s_mov_b32 s42, s54
    s_mov_b32 s65, s74
    s_branch L_stubV_back
L_rare0:
    s_nop 7
    v_max3_f32 v244, v64, v65, v66
    v_max3_f32 v244, v244, v67, v68
    v_max3_f32 v244, v244, v69, v70
    v_max_f32 v244, v244, v71
    v_mov_b32 v24, v244
    v_mov_b32 v25, v244
    s_nop 1
    v_permlane16_swap_b32 v24, v25
    s_nop 1
    v_max_f32 v244, v24, v25
    v_mov_b32 v24, v244
    v_mov_b32 v25, v244
    s_nop 1
    v_permlane32_swap_b32 v24, v25
    s_nop 1
    v_max_f32 v244, v24, v25
    v_max_f32 v244, 0, v244
    v_exp_f32 v245, -v244
    v_sub_f32 v96, v96, v244
    v_sub_f32 v97, v97, v244
    v_sub_f32 v98, v98, v244
    v_sub_f32 v99, v99, v244
    v_sub_f32 v32, v32, v244
    v_sub_f32 v33, v33, v244
    v_sub_f32 v34, v34, v244
    v_sub_f32 v35, v35, v244
    v_sub_f32 v36, v36, v244
    v_sub_f32 v37, v37, v244
    v_sub_f32 v38, v38, v244
    v_sub_f32 v39, v39, v244
    v_mul_f32 v20, v20, v245
    v_mul_f32 v160, v160, v245
    v_mul_f32 v161, v161, v245
    v_mul_f32 v162, v162, v245
    v_mul_f32 v163, v163, v245
    v_mul_f32 v164, v164, v245
    v_mul_f32 v165, v165, v245
    v_mul_f32 v166, v166, v245
    v_mul_f32 v167, v167, v245
    v_mul_f32 v168, v168, v245
    v_mul_f32 v169, v169, v245
    v_mul_f32 v170, v170, v245
    v_mul_f32 v171, v171, v245
    v_mul_f32 v172, v172, v245
    v_mul_f32 v173, v173, v245
    v_mul_f32 v174, v174, v245
    v_mul_f32 v175, v175, v245
    v_mul_f32 v176, v176, v245
    v_mul_f32 v177, v177, v245
    v_mul_f32 v178, v178, v245
    v_mul_f32 v179, v179, v245
    v_mul_f32 v180, v180, v245
    v_mul_f32 v181, v181, v245
    v_mul_f32 v182, v182, v245
    v_mul_f32 v183, v183, v245
    v_mul_f32 v184, v184, v245
    v_mul_f32 v185, v185, v245
    v_mul_f32 v186, v186, v245
    v_mul_f32 v187, v187, v245
    v_mul_f32 v188, v188, v245
    v_mul_f32 v189, v189, v245
    v_mul_f32 v190, v190, v245
    v_mul_f32 v191, v191, v245
    v_sub_f32 v24, v64, v244
    v_sub_f32 v25, v65, v244
    v_sub_f32 v26, v66, v244
    v_sub_f32 v27, v67, v244
    v_sub_f32 v28, v68, v244
    v_sub_f32 v29, v69, v244
    v_sub_f32 v30, v70, v244
    v_sub_f32 v31, v71, v244
    v_exp_f32 v24, v24
    v_exp_f32 v25, v25
    v_exp_f32 v26, v26
    v_exp_f32 v27, v27
    v_exp_f32 v28, v28
    v_exp_f32 v29, v29
    v_exp_f32 v30, v30
    v_exp_f32 v31, v31
    s_nop 0
    v_cvt_pk_bf16_f32 v144, v24, v25
    v_cvt_pk_bf16_f32 v145, v26, v27
    v_cvt_pk_bf16_f32 v146, v28, v29
    v_cvt_pk_bf16_f32 v147, v30, v31
    s_nop 1
    v_mfma_f32_16x16x32_bf16 v[112:115], v[248:251], v[144:147], 0
    v_max3_f32 v244, v72, v73, v74
    v_max3_f32 v244, v244, v75, v76
    v_max3_f32 v244, v244, v77, v78
    v_max_f32 v244, v244, v79
    v_mov_b32 v24, v244
    v_mov_b32 v25, v244
    s_nop 1
    v_permlane16_swap_b32 v24, v25
    s_nop 1
    v_max_f32 v244, v24, v25
    v_mov_b32 v24, v244
    v_mov_b32 v25, v244
    s_nop 1
    v_permlane32_swap_b32 v24, v25
    s_nop 1
    v_max_f32 v244, v24, v25
    v_max_f32 v244, 0, v244
    v_exp_f32 v245, -v244
    v_sub_f32 v100, v100, v244
    v_sub_f32 v101, v101, v244
    v_sub_f32 v102, v102, v244
    v_sub_f32 v103, v103, v244
    v_sub_f32 v40, v40, v244
    v_sub_f32 v41, v41, v244
    v_sub_f32 v42, v42, v244
    v_sub_f32 v43, v43, v244
    v_sub_f32 v44, v44, v244
    v_sub_f32 v45, v45, v244
    v_sub_f32 v46, v46, v244
    v_sub_f32 v47, v47, v244
    v_mul_f32 v21, v21, v245
    v_mul_f32 v192, v192, v245
    v_mul_f32 v193, v193, v245
    v_mul_f32 v194, v194, v245
    v_mul_f32 v195, v195, v245
    v_mul_f32 v196, v196, v245
    v_mul_f32 v197, v197, v245
    v_mul_f32 v198, v198, v245
    v_mul_f32 v199, v199, v245
    v_mul_f32 v200, v200, v245
    v_mul_f32 v201, v201, v245
    v_mul_f32 v202, v202, v245
    v_mul_f32 v203, v203, v245
    v_mul_f32 v204, v204, v245
    v_mul_f32 v205, v205, v245
    v_mul_f32 v206, v206, v245
    v_mul_f32 v207, v207, v245
    v_mul_f32 v208, v208, v245
    v_mul_f32 v209, v209, v245
    v_mul_f32 v210, v210, v245
    v_mul_f32 v211, v211, v245
    v_mul_f32 v212, v212, v245
    v_mul_f32 v213, v213, v245
    v_mul_f32 v214, v214, v245
    v_mul_f32 v215, v215, v245
    v_mul_f32 v216, v216, v245
    v_mul_f32 v217, v217, v245
    v_mul_f32 v218, v218, v245
    v_mul_f32 v219, v219, v245
    v_mul_f32 v220, v220, v245
    v_mul_f32 v221, v221, v245
    v_mul_f32 v222, v222, v245
    v_mul_f32 v223, v223, v245
    v_sub_f32 v24, v72, v244
    v_sub_f32 v25, v73, v244
    v_sub_f32 v26, v74, v244
    v_sub_f32 v27, v75, v244
    v_sub_f32 v28, v76, v244
    v_sub_f32 v29, v77, v244
    v_sub_f32 v30, v78, v244
    v_sub_f32 v31, v79, v244
    v_exp_f32 v24, v24
    v_exp_f32 v25, v25
    v_exp_f32 v26, v26
    v_exp_f32 v27, v27
    v_exp_f32 v28, v28
    v_exp_f32 v29, v29
    v_exp_f32 v30, v30
    v_exp_f32 v31, v31
    s_nop 0
    v_cvt_pk_bf16_f32 v148, v24, v25
    v_cvt_pk_bf16_f32 v149, v26, v27
    v_cvt_pk_bf16_f32 v150, v28, v29
    v_cvt_pk_bf16_f32 v151, v30, v31
    s_nop 1
    v_mfma_f32_16x16x32_bf16 v[116:119], v[248:251], v[148:151], 0
    v_max3_f32 v244, v80, v81, v82
    v_max3_f32 v244, v244, v83, v84
    v_max3_f32 v244, v244, v85, v86
    v_max_f32 v244, v244, v87
    v_mov_b32 v24, v244
    v_mov_b32 v25, v244
    s_nop 1
    v_permlane16_swap_b32 v24, v25
    s_nop 1
    v_max_f32 v244, v24, v25
    v_mov_b32 v24, v244
    v_mov_b32 v25, v244
    s_nop 1
    v_permlane32_swap_b32 v24, v25
    s_nop 1
    v_max_f32 v244, v24, v25
    v_max_f32 v244, 0, v244
    v_exp_f32 v245, -v244
    v_sub_f32 v104, v104, v244
    v_sub_f32 v105, v105, v244
    v_sub_f32 v106, v106, v244
    v_sub_f32 v107, v107, v244
    v_sub_f32 v48, v48, v244
    v_sub_f32 v49, v49, v244
    v_sub_f32 v50, v50, v244
    v_sub_f32 v51, v51, v244
    v_sub_f32 v52, v52, v244
    v_sub_f32 v53, v53, v244
    v_sub_f32 v54, v54, v244
    v_sub_f32 v55, v55, v244
    v_mul_f32 v22, v22, v245
    v_accvgpr_read_b32 v246, a0
    v_mul_f32 v246, v246, v245
    v_accvgpr_write_b32 a0, v246
    v_accvgpr_read_b32 v246, a1
    v_mul_f32 v246, v246, v245
    v_accvgpr_write_b32 a1, v246
    v_accvgpr_read_b32 v246, a2
    v_mul_f32 v246, v246, v245
    v_accvgpr_write_b32 a2, v246
    v_accvgpr_read_b32 v246, a3
    v_mul_f32 v246, v246, v245
    v_accvgpr_write_b32 a3, v246
    v_accvgpr_read_b32 v246, a4
    v_mul_f32 v246, v246, v245
    v_accvgpr_write_b32 a4, v246
    v_accvgpr_read_b32 v246, a5
    v_mul_f32 v246, v246, v245
    v_accvgpr_write_b32 a5, v246
    v_accvgpr_read_b32 v246, a6
    v_mul_f32 v246, v246, v245
    v_accvgpr_write_b32 a6, v246
    v_accvgpr_read_b32 v246, a7
    v_mul_f32 v246, v246, v245
    v_accvgpr_write_b32 a7, v246
    v_accvgpr_read_b32 v246, a8
    v_mul_f32 v246, v246, v245
    v_accvgpr_write_b32 a8, v246
    v_accvgpr_read_b32 v246, a9
    v_mul_f32 v246, v246, v245
    v_accvgpr_write_b32 a9, v246
    v_accvgpr_read_b32 v246, a10
    v_mul_f32 v246, v246, v245
    v_accvgpr_write_b32 a10, v246
    v_accvgpr_read_b32 v246, a11
    v_mul_f32 v246, v246, v245
    v_accvgpr_write_b32 a11, v246
    v_accvgpr_read_b32 v246, a12
    v_mul_f32 v246, v246, v245
    v_accvgpr_write_b32 a12, v246
    v_accvgpr_read_b32 v246, a13
    v_mul_f32 v246, v246, v245
    v_accvgpr_write_b32 a13, v246
    v_accvgpr_read_b32 v246, a14
    v_mul_f32 v246, v246, v245
    v_accvgpr_write_b32 a14, v246
    v_accvgpr_read_b32 v246, a15
    v_mul_f32 v246, v246, v245
    v_accvgpr_write_b32 a15, v246
    v_accvgpr_read_b32 v246, a16
    v_mul_f32 v246, v246, v245
    v_accvgpr_write_b32 a16, v246
    v_accvgpr_read_b32 v246, a17
    v_mul_f32 v246, v246, v245
    v_accvgpr_write_b32 a17, v246
    v_accvgpr_read_b32 v246, a18
    v_mul_f32 v246, v246, v245
    v_accvgpr_write_b32 a18, v246
    v_accvgpr_read_b32 v246, a19
    v_mul_f32 v246, v246, v245
    v_accvgpr_write_b32 a19, v246
    v_accvgpr_read_b32 v246, a20
    v_mul_f32 v246, v246, v245
    v_accvgpr_write_b32 a20, v246
    v_accvgpr_read_b32 v246, a21
    v_mul_f32 v246, v246, v245
    v_accvgpr_write_b32 a21, v246
    v_accvgpr_read_b32 v246, a22
    v_mul_f32 v246, v246, v245
    v_accvgpr_write_b32 a22, v246
    v_accvgpr_read_b32 v246, a23
    v_mul_f32 v246, v246, v245
    v_accvgpr_write_b32 a23, v246
    v_accvgpr_read_b32 v246, a24
    v_mul_f32 v246, v246, v245
    v_accvgpr_write_b32 a24, v246
    v_accvgpr_read_b32 v246, a25
    v_mul_f32 v246, v246, v245
    v_accvgpr_write_b32 a25, v246
    v_accvgpr_read_b32 v246, a26
    v_mul_f32 v246, v246, v245
    v_accvgpr_write_b32 a26, v246
    v_accvgpr_read_b32 v246, a27
    v_mul_f32 v246, v246, v245
    v_accvgpr_write_b32 a27, v246
    v_accvgpr_read_b32 v246, a28
    v_mul_f32 v246, v246, v245
    v_accvgpr_write_b32 a28, v246
    v_accvgpr_read_b32 v246, a29
    v_mul_f32 v246, v246, v245
    v_accvgpr_write_b32 a29, v246
    v_accvgpr_read_b32 v246, a30
    v_mul_f32 v246, v246, v245
    v_accvgpr_write_b32 a30, v246
    v_accvgpr_read_b32 v246, a31
    v_mul_f32 v246, v246, v245
    v_accvgpr_write_b32 a31, v246
    v_sub_f32 v24, v80, v244
    v_sub_f32 v25, v81, v244
    v_sub_f32 v26, v82, v244
    v_sub_f32 v27, v83, v244
    v_sub_f32 v28, v84, v244
    v_sub_f32 v29, v85, v244
    v_sub_f32 v30, v86, v244
    v_sub_f32 v31, v87, v244
    v_exp_f32 v24, v24
    v_exp_f32 v25, v25
    v_exp_f32 v26, v26
    v_exp_f32 v27, v27
    v_exp_f32 v28, v28
    v_exp_f32 v29, v29
    v_exp_f32 v30, v30
    v_exp_f32 v31, v31
    s_nop 0
    v_cvt_pk_bf16_f32 v152, v24, v25
    v_cvt_pk_bf16_f32 v153, v26, v27
    v_cvt_pk_bf16_f32 v154, v28, v29
    v_cvt_pk_bf16_f32 v155, v30, v31
    s_nop 1
    v_mfma_f32_16x16x32_bf16 v[120:123], v[248:251], v[152:155], 0
    v_max3_f32 v244, v88, v89, v90
    v_max3_f32 v244, v244, v91, v92
    v_max3_f32 v244, v244, v93, v94
    v_max_f32 v244, v244, v95
    v_mov_b32 v24, v244
    v_mov_b32 v25, v244
    s_nop 1
    v_permlane16_swap_b32 v24, v25
    s_nop 1
    v_max_f32 v244, v24, v25
    v_mov_b32 v24, v244
    v_mov_b32 v25, v244
    s_nop 1
    v_permlane32_swap_b32 v24, v25
    s_nop 1
    v_max_f32 v244, v24, v25
    v_max_f32 v244, 0, v244
    v_exp_f32 v245, -v244
    v_sub_f32 v108, v108, v244
    v_sub_f32 v109, v109, v244
    v_sub_f32 v110, v110, v244
    v_sub_f32 v111, v111, v244
    v_sub_f32 v56, v56, v244
    v_sub_f32 v57, v57, v244
    v_sub_f32 v58, v58, v244
    v_sub_f32 v59, v59, v244
    v_sub_f32 v60, v60, v244
    v_sub_f32 v61, v61, v244
    v_sub_f32 v62, v62, v244
    v_sub_f32 v63, v63, v244
    v_mul_f32 v23, v23, v245
    v_accvgpr_read_b32 v246, a32
    v_mul_f32 v246, v246, v245
    v_accvgpr_write_b32 a32, v246
    v_accvgpr_read_b32 v246, a33
    v_mul_f32 v246, v246, v245
    v_accvgpr_write_b32 a33, v246
    v_accvgpr_read_b32 v246, a34
    v_mul_f32 v246, v246, v245
    v_accvgpr_write_b32 a34, v246
    v_accvgpr_read_b32 v246, a35
    v_mul_f32 v246, v246, v245
    v_accvgpr_write_b32 a35, v246
    v_accvgpr_read_b32 v246, a36
    v_mul_f32 v246, v246, v245
    v_accvgpr_write_b32 a36, v246
    v_accvgpr_read_b32 v246, a37
    v_mul_f32 v246, v246, v245
    v_accvgpr_write_b32 a37, v246
    v_accvgpr_read_b32 v246, a38
    v_mul_f32 v246, v246, v245
    v_accvgpr_write_b32 a38, v246
    v_accvgpr_read_b32 v246, a39
    v_mul_f32 v246, v246, v245
    v_accvgpr_write_b32 a39, v246
    v_accvgpr_read_b32 v246, a40
    v_mul_f32 v246, v246, v245
    v_accvgpr_write_b32 a40, v246
    v_accvgpr_read_b32 v246, a41
    v_mul_f32 v246, v246, v245
    v_accvgpr_write_b32 a41, v246
    v_accvgpr_read_b32 v246, a42
    v_mul_f32 v246, v246, v245
    v_accvgpr_write_b32 a42, v246
    v_accvgpr_read_b32 v246, a43
    v_mul_f32 v246, v246, v245
    v_accvgpr_write_b32 a43, v246
    v_accvgpr_read_b32 v246, a44
    v_mul_f32 v246, v246, v245
    v_accvgpr_write_b32 a44, v246
    v_accvgpr_read_b32 v246, a45
    v_mul_f32 v246, v246, v245
    v_accvgpr_write_b32 a45, v246
    v_accvgpr_read_b32 v246, a46
    v_mul_f32 v246, v246, v245
    v_accvgpr_write_b32 a46, v246
    v_accvgpr_read_b32 v246, a47
    v_mul_f32 v246, v246, v245
    v_accvgpr_write_b32 a47, v246
    v_accvgpr_read_b32 v246, a48
    v_mul_f32 v246, v246, v245
    v_accvgpr_write_b32 a48, v246
    v_accvgpr_read_b32 v246, a49
    v_mul_f32 v246, v246, v245
    v_accvgpr_write_b32 a49, v246
    v_accvgpr_read_b32 v246, a50
    v_mul_f32 v246, v246, v245
    v_accvgpr_write_b32 a50, v246
    v_accvgpr_read_b32 v246, a51
    v_mul_f32 v246, v246, v245
    v_accvgpr_write_b32 a51, v246
    v_accvgpr_read_b32 v246, a52
    v_mul_f32 v246, v246, v245
    v_accvgpr_write_b32 a52, v246
    v_accvgpr_read_b32 v246, a53
    v_mul_f32 v246, v246, v245
    v_accvgpr_write_b32 a53, v246
    v_accvgpr_read_b32 v246, a54
    v_mul_f32 v246, v246, v245
    v_accvgpr_write_b32 a54, v246
    v_accvgpr_read_b32 v246, a55
    v_mul_f32 v246, v246, v245
    v_accvgpr_write_b32 a55, v246
    v_accvgpr_read_b32 v246, a56
    v_mul_f32 v246, v246, v245
    v_accvgpr_write_b32 a56, v246
    v_accvgpr_read_b32 v246, a57
    v_mul_f32 v246, v246, v245
    v_accvgpr_write_b32 a57, v246
    v_accvgpr_read_b32 v246, a58
    v_mul_f32 v246, v246, v245
    v_accvgpr_write_b32 a58, v246
    v_accvgpr_read_b32 v246, a59
    v_mul_f32 v246, v246, v245
    v_accvgpr_write_b32 a59, v246
    v_accvgpr_read_b32 v246, a60
    v_mul_f32 v246, v246, v245
    v_accvgpr_write_b32 a60, v246
    v_accvgpr_read_b32 v246, a61
    v_mul_f32 v246, v246, v245
    v_accvgpr_write_b32 a61, v246
    v_accvgpr_read_b32 v246, a62
    v_mul_f32 v246, v246, v245
    v_accvgpr_write_b32 a62, v246
    v_accvgpr_read_b32 v246, a63
    v_mul_f32 v246, v246, v245
    v_accvgpr_write_b32 a63, v246
    v_sub_f32 v24, v88, v244
    v_sub_f32 v25, v89, v244
    v_sub_f32 v26, v90, v244
    v_sub_f32 v27, v91, v244
    v_sub_f32 v28, v92, v244
    v_sub_f32 v29, v93, v244
    v_sub_f32 v30, v94, v244
    v_sub_f32 v31, v95, v244
    v_exp_f32 v24, v24
    v_exp_f32 v25, v25
    v_exp_f32 v26, v26
    v_exp_f32 v27, v27
    v_exp_f32 v28, v28
    v_exp_f32 v29, v29
    v_exp_f32 v30, v30
    v_exp_f32 v31, v31
    s_nop 0
    v_cvt_pk_bf16_f32 v156, v24, v25
    v_cvt_pk_bf16_f32 v157, v26, v27
    v_cvt_pk_bf16_f32 v158, v28, v29
    v_cvt_pk_bf16_f32 v159, v30, v31
    s_nop 1
    v_mfma_f32_16x16x32_bf16 v[124:127], v[248:251], v[156:159], 0
    s_nop 7
    s_branch L_back0
L_rare1:
    s_nop 7
    v_max3_f32 v244, v32, v33, v34
    v_max3_f32 v244, v244, v35, v36
    v_max3_f32 v244, v244, v37, v38
    v_max_f32 v244, v244, v39
    v_mov_b32 v24, v244
    v_mov_b32 v25, v244
    s_nop 1
    v_permlane16_swap_b32 v24, v25
    s_nop 1
    v_max_f32 v244, v24, v25
    v_mov_b32 v24, v244
    v_mov_b32 v25, v244
    s_nop 1
    v_permlane32_swap_b32 v24, v25
    s_nop 1
    v_max_f32 v244, v24, v25
    v_max_f32 v244, 0, v244
    v_exp_f32 v245, -v244
    v_sub_f32 v96, v96, v244
    v_sub_f32 v97, v97, v244
    v_sub_f32 v98, v98, v244
    v_sub_f32 v99, v99, v244
    v_sub_f32 v64, v64, v244
    v_sub_f32 v65, v65, v244
    v_sub_f32 v66, v66, v244
    v_sub_f32 v67, v67, v244
    v_sub_f32 v68, v68, v244
    v_sub_f32 v69, v69, v244
    v_sub_f32 v70, v70, v244
    v_sub_f32 v71, v71, v244
    v_mul_f32 v20, v20, v245
    v_mul_f32 v160, v160, v245
    v_mul_f32 v161, v161, v245
    v_mul_f32 v162, v162, v245
    v_mul_f32 v163, v163, v245
    v_mul_f32 v164, v164, v245
    v_mul_f32 v165, v165, v245
    v_mul_f32 v166, v166, v245
    v_mul_f32 v167, v167, v245
    v_mul_f32 v168, v168, v245
    v_mul_f32 v169, v169, v245
    v_mul_f32 v170, v170, v245
    v_mul_f32 v171, v171, v245
    v_mul_f32 v172, v172, v245
    v_mul_f32 v173, v173, v245
    v_mul_f32 v174, v174, v245
    v_mul_f32 v175, v175, v245
    v_mul_f32 v176, v176, v245
    v_mul_f32 v177, v177, v245
    v_mul_f32 v178, v178, v245
    v_mul_f32 v179, v179, v245
    v_mul_f32 v180, v180, v245
    v_mul_f32 v181, v181, v245
    v_mul_f32 v182, v182, v245
    v_mul_f32 v183, v183, v245
    v_mul_f32 v184, v184, v245
    v_mul_f32 v185, v185, v245
    v_mul_f32 v186, v186, v245
    v_mul_f32 v187, v187, v245
    v_mul_f32 v188, v188, v245
    v_mul_f32 v189, v189, v245
    v_mul_f32 v190, v190, v245
    v_mul_f32 v191, v191, v245
    v_sub_f32 v24, v32, v244
    v_sub_f32 v25, v33, v244
    v_sub_f32 v26, v34, v244
    v_sub_f32 v27, v35, v244
    v_sub_f32 v28, v36, v244
    v_sub_f32 v29, v37, v244
    v_sub_f32 v30, v38, v244
    v_sub_f32 v31, v39, v244
    v_exp_f32 v24, v24
    v_exp_f32 v25, v25
    v_exp_f32 v26, v26
    v_exp_f32 v27, v27
    v_exp_f32 v28, v28
    v_exp_f32 v29, v29
    v_exp_f32 v30, v30
    v_exp_f32 v31, v31
    s_nop 0
    v_cvt_pk_bf16_f32 v128, v24, v25
    v_cvt_pk_bf16_f32 v129, v26, v27
    v_cvt_pk_bf16_f32 v130, v28, v29
    v_cvt_pk_bf16_f32 v131, v30, v31
    s_nop 1
    v_mfma_f32_16x16x32_bf16 v[112:115], v[248:251], v[128:131], 0
    v_max3_f32 v244, v40, v41, v42
    v_max3_f32 v244, v244, v43, v44
    v_max3_f32 v244, v244, v45, v46
    v_max_f32 v244, v244, v47
    v_mov_b32 v24, v244
    v_mov_b32 v25, v244
    s_nop 1
    v_permlane16_swap_b32 v24, v25
    s_nop 1
    v_max_f32 v244, v24, v25
    v_mov_b32 v24, v244
    v_mov_b32 v25, v244
    s_nop 1
    v_permlane32_swap_b32 v24, v25
    s_nop 1
    v_max_f32 v244, v24, v25
    v_max_f32 v244, 0, v244
    v_exp_f32 v245, -v244
    v_sub_f32 v100, v100, v244
    v_sub_f32 v101, v101, v244
    v_sub_f32 v102, v102, v244
    v_sub_f32 v103, v103, v244
    v_sub_f32 v72, v72, v244
    v_sub_f32 v73, v73, v244
    v_sub_f32 v74, v74, v244
    v_sub_f32 v75, v75, v244
    v_sub_f32 v76, v76, v244
    v_sub_f32 v77, v77, v244
    v_sub_f32 v78, v78, v244
    v_sub_f32 v79, v79, v244
    v_mul_f32 v21, v21, v245
    v_mul_f32 v192, v192, v245
    v_mul_f32 v193, v193, v245
    v_mul_f32 v194, v194, v245
    v_mul_f32 v195, v195, v245
    v_mul_f32 v196, v196, v245
    v_mul_f32 v197, v197, v245
    v_mul_f32 v198, v198, v245
    v_mul_f32 v199, v199, v245
    v_mul_f32 v200, v200, v245
    v_mul_f32 v201, v201, v245
    v_mul_f32 v202, v202, v245
    v_mul_f32 v203, v203, v245
    v_mul_f32 v204, v204, v245
    v_mul_f32 v205, v205, v245
    v_mul_f32 v206, v206, v245
    v_mul_f32 v207, v207, v245
    v_mul_f32 v208, v208, v245
    v_mul_f32 v209, v209, v245
    v_mul_f32 v210, v210, v245
    v_mul_f32 v211, v211, v245
    v_mul_f32 v212, v212, v245
    v_mul_f32 v213, v213, v245
    v_mul_f32 v214, v214, v245
    v_mul_f32 v215, v215, v245
    v_mul_f32 v216, v216, v245
    v_mul_f32 v217, v217, v245
    v_mul_f32 v218, v218, v245
    v_mul_f32 v219, v219, v245
    v_mul_f32 v220, v220, v245
    v_mul_f32 v221, v221, v245
    v_mul_f32 v222, v222, v245
    v_mul_f32 v223, v223, v245
    v_sub_f32 v24, v40, v244
    v_sub_f32 v25, v41, v244
    v_sub_f32 v26, v42, v244
    v_sub_f32 v27, v43, v244
    v_sub_f32 v28, v44, v244
    v_sub_f32 v29, v45, v244
    v_sub_f32 v30, v46, v244
    v_sub_f32 v31, v47, v244
    v_exp_f32 v24, v24
    v_exp_f32 v25, v25
    v_exp_f32 v26, v26
    v_exp_f32 v27, v27
    v_exp_f32 v28, v28
    v_exp_f32 v29, v29
    v_exp_f32 v30, v30
    v_exp_f32 v31, v31
    s_nop 0
    v_cvt_pk_bf16_f32 v132, v24, v25
    v_cvt_pk_bf16_f32 v133, v26, v27
    v_cvt_pk_bf16_f32 v134, v28, v29
    v_cvt_pk_bf16_f32 v135, v30, v31
    s_nop 1
    v_mfma_f32_16x16x32_bf16 v[116:119], v[248:251], v[132:135], 0
    v_max3_f32 v244, v48, v49, v50
    v_max3_f32 v244, v244, v51, v52
    v_max3_f32 v244, v244, v53, v54
    v_max_f32 v244, v244, v55
    v_mov_b32 v24, v244
    v_mov_b32 v25, v244
    s_nop 1
    v_permlane16_swap_b32 v24, v25
    s_nop 1
    v_max_f32 v244, v24, v25
    v_mov_b32 v24, v244
    v_mov_b32 v25, v244
    s_nop 1
    v_permlane32_swap_b32 v24, v25
    s_nop 1
    v_max_f32 v244, v24, v25
    v_max_f32 v244, 0, v244
    v_exp_f32 v245, -v244
    v_sub_f32 v104, v104, v244
    v_sub_f32 v105, v105, v244
    v_sub_f32 v106, v106, v244
    v_sub_f32 v107, v107, v244
    v_sub_f32 v80, v80, v244
    v_sub_f32 v81, v81, v244
    v_sub_f32 v82, v82, v244
    v_sub_f32 v83, v83, v244
    v_sub_f32 v84, v84, v244
    v_sub_f32 v85, v85, v244
    v_sub_f32 v86, v86, v244
    v_sub_f32 v87, v87, v244
    v_mul_f32 v22, v22, v245
    v_accvgpr_read_b32 v246, a0
    v_mul_f32 v246, v246, v245
    v_accvgpr_write_b32 a0, v246
    v_accvgpr_read_b32 v246, a1
    v_mul_f32 v246, v246, v245
    v_accvgpr_write_b32 a1, v246
    v_accvgpr_read_b32 v246, a2
    v_mul_f32 v246, v246, v245
    v_accvgpr_write_b32 a2, v246
    v_accvgpr_read_b32 v246, a3
    v_mul_f32 v246, v246, v245
    v_accvgpr_write_b32 a3, v246
    v_accvgpr_read_b32 v246, a4
    v_mul_f32 v246, v246, v245
    v_accvgpr_write_b32 a4, v246
    v_accvgpr_read_b32 v246, a5
    v_mul_f32 v246, v246, v245
    v_accvgpr_write_b32 a5, v246
    v_accvgpr_read_b32 v246, a6
    v_mul_f32 v246, v246, v245
    v_accvgpr_write_b32 a6, v246
    v_accvgpr_read_b32 v246, a7
    v_mul_f32 v246, v246, v245
    v_accvgpr_write_b32 a7, v246
    v_accvgpr_read_b32 v246, a8
    v_mul_f32 v246, v246, v245
    v_accvgpr_write_b32 a8, v246
    v_accvgpr_read_b32 v246, a9
    v_mul_f32 v246, v246, v245
    v_accvgpr_write_b32 a9, v246
    v_accvgpr_read_b32 v246, a10
    v_mul_f32 v246, v246, v245
    v_accvgpr_write_b32 a10, v246
    v_accvgpr_read_b32 v246, a11
    v_mul_f32 v246, v246, v245
    v_accvgpr_write_b32 a11, v246
    v_accvgpr_read_b32 v246, a12
    v_mul_f32 v246, v246, v245
    v_accvgpr_write_b32 a12, v246
    v_accvgpr_read_b32 v246, a13
    v_mul_f32 v246, v246, v245
    v_accvgpr_write_b32 a13, v246
    v_accvgpr_read_b32 v246, a14
    v_mul_f32 v246, v246, v245
    v_accvgpr_write_b32 a14, v246
    v_accvgpr_read_b32 v246, a15
    v_mul_f32 v246, v246, v245
    v_accvgpr_write_b32 a15, v246
    v_accvgpr_read_b32 v246, a16
    v_mul_f32 v246, v246, v245
    v_accvgpr_write_b32 a16, v246
    v_accvgpr_read_b32 v246, a17
    v_mul_f32 v246, v246, v245
    v_accvgpr_write_b32 a17, v246
    v_accvgpr_read_b32 v246, a18
    v_mul_f32 v246, v246, v245
    v_accvgpr_write_b32 a18, v246
    v_accvgpr_read_b32 v246, a19
    v_mul_f32 v246, v246, v245
    v_accvgpr_write_b32 a19, v246
    v_accvgpr_read_b32 v246, a20
    v_mul_f32 v246, v246, v245
    v_accvgpr_write_b32 a20, v246
    v_accvgpr_read_b32 v246, a21
    v_mul_f32 v246, v246, v245
    v_accvgpr_write_b32 a21, v246
    v_accvgpr_read_b32 v246, a22
    v_mul_f32 v246, v246, v245
    v_accvgpr_write_b32 a22, v246
    v_accvgpr_read_b32 v246, a23
    v_mul_f32 v246, v246, v245
    v_accvgpr_write_b32 a23, v246
    v_accvgpr_read_b32 v246, a24
    v_mul_f32 v246, v246, v245
    v_accvgpr_write_b32 a24, v246
    v_accvgpr_read_b32 v246, a25
    v_mul_f32 v246, v246, v245
    v_accvgpr_write_b32 a25, v246
    v_accvgpr_read_b32 v246, a26
    v_mul_f32 v246, v246, v245
    v_accvgpr_write_b32 a26, v246
    v_accvgpr_read_b32 v246, a27
    v_mul_f32 v246, v246, v245
    v_accvgpr_write_b32 a27, v246
    v_accvgpr_read_b32 v246, a28
    v_mul_f32 v246, v246, v245
    v_accvgpr_write_b32 a28, v246
    v_accvgpr_read_b32 v246, a29
    v_mul_f32 v246, v246, v245
    v_accvgpr_write_b32 a29, v246
    v_accvgpr_read_b32 v246, a30
    v_mul_f32 v246, v246, v245
    v_accvgpr_write_b32 a30, v246
    v_accvgpr_read_b32 v246, a31
    v_mul_f32 v246, v246, v245
    v_accvgpr_write_b32 a31, v246
    v_sub_f32 v24, v48, v244
    v_sub_f32 v25, v49, v244
    v_sub_f32 v26, v50, v244
    v_sub_f32 v27, v51, v244
    v_sub_f32 v28, v52, v244
    v_sub_f32 v29, v53, v244
    v_sub_f32 v30, v54, v244
    v_sub_f32 v31, v55, v244
    v_exp_f32 v24, v24
    v_exp_f32 v25, v25
    v_exp_f32 v26, v26
    v_exp_f32 v27, v27
    v_exp_f32 v28, v28
    v_exp_f32 v29, v29
    v_exp_f32 v30, v30
    v_exp_f32 v31, v31
    s_nop 0
    v_cvt_pk_bf16_f32 v136, v24, v25
    v_cvt_pk_bf16_f32 v137, v26, v27
    v_cvt_pk_bf16_f32 v138, v28, v29
    v_cvt_pk_bf16_f32 v139, v30, v31
    s_nop 1
    v_mfma_f32_16x16x32_bf16 v[120:123], v[248:251], v[136:139], 0
    v_max3_f32 v244, v56, v57, v58
    v_max3_f32 v244, v244, v59, v60
    v_max3_f32 v244, v244, v61, v62
    v_max_f32 v244, v244, v63
    v_mov_b32 v24, v244
    v_mov_b32 v25, v244
    s_nop 1
    v_permlane16_swap_b32 v24, v25
    s_nop 1
    v_max_f32 v244, v24, v25
    v_mov_b32 v24, v244
    v_mov_b32 v25, v244
    s_nop 1
    v_permlane32_swap_b32 v24, v25
    s_nop 1
    v_max_f32 v244, v24, v25
    v_max_f32 v244, 0, v244
    v_exp_f32 v245, -v244
    v_sub_f32 v108, v108, v244
    v_sub_f32 v109, v109, v244
    v_sub_f32 v110, v110, v244
    v_sub_f32 v111, v111, v244
    v_sub_f32 v88, v88, v244
    v_sub_f32 v89, v89, v244
    v_sub_f32 v90, v90, v244
    v_sub_f32 v91, v91, v244
    v_sub_f32 v92, v92, v244
    v_sub_f32 v93, v93, v244
    v_sub_f32 v94, v94, v244
    v_sub_f32 v95, v95, v244
    v_mul_f32 v23, v23, v245
    v_accvgpr_read_b32 v246, a32
    v_mul_f32 v246, v246, v245
    v_accvgpr_write_b32 a32, v246
    v_accvgpr_read_b32 v246, a33
    v_mul_f32 v246, v246, v245
    v_accvgpr_write_b32 a33, v246
    v_accvgpr_read_b32 v246, a34
    v_mul_f32 v246, v246, v245
    v_accvgpr_write_b32 a34, v246
    v_accvgpr_read_b32 v246, a35
    v_mul_f32 v246, v246, v245
    v_accvgpr_write_b32 a35, v246
    v_accvgpr_read_b32 v246, a36
    v_mul_f32 v246, v246, v245
    v_accvgpr_write_b32 a36, v246
    v_accvgpr_read_b32 v246, a37
    v_mul_f32 v246, v246, v245
    v_accvgpr_write_b32 a37, v246
    v_accvgpr_read_b32 v246, a38
    v_mul_f32 v246, v246, v245
    v_accvgpr_write_b32 a38, v246
    v_accvgpr_read_b32 v246, a39
    v_mul_f32 v246, v246, v245
    v_accvgpr_write_b32 a39, v246
    v_accvgpr_read_b32 v246, a40
    v_mul_f32 v246, v246, v245
    v_accvgpr_write_b32 a40, v246
    v_accvgpr_read_b32 v246, a41
    v_mul_f32 v246, v246, v245
    v_accvgpr_write_b32 a41, v246
    v_accvgpr_read_b32 v246, a42
    v_mul_f32 v246, v246, v245
    v_accvgpr_write_b32 a42, v246
    v_accvgpr_read_b32 v246, a43
    v_mul_f32 v246, v246, v245
    v_accvgpr_write_b32 a43, v246
    v_accvgpr_read_b32 v246, a44
    v_mul_f32 v246, v246, v245
    v_accvgpr_write_b32 a44, v246
    v_accvgpr_read_b32 v246, a45
    v_mul_f32 v246, v246, v245
    v_accvgpr_write_b32 a45, v246
    v_accvgpr_read_b32 v246, a46
    v_mul_f32 v246, v246, v245
    v_accvgpr_write_b32 a46, v246
    v_accvgpr_read_b32 v246, a47
    v_mul_f32 v246, v246, v245
    v_accvgpr_write_b32 a47, v246
    v_accvgpr_read_b32 v246, a48
    v_mul_f32 v246, v246, v245
    v_accvgpr_write_b32 a48, v246
    v_accvgpr_read_b32 v246, a49
    v_mul_f32 v246, v246, v245
    v_accvgpr_write_b32 a49, v246
    v_accvgpr_read_b32 v246, a50
    v_mul_f32 v246, v246, v245
    v_accvgpr_write_b32 a50, v246
    v_accvgpr_read_b32 v246, a51
    v_mul_f32 v246, v246, v245
    v_accvgpr_write_b32 a51, v246
    v_accvgpr_read_b32 v246, a52
    v_mul_f32 v246, v246, v245
    v_accvgpr_write_b32 a52, v246
    v_accvgpr_read_b32 v246, a53
    v_mul_f32 v246, v246, v245
    v_accvgpr_write_b32 a53, v246
    v_accvgpr_read_b32 v246, a54
    v_mul_f32 v246, v246, v245
    v_accvgpr_write_b32 a54, v246
    v_accvgpr_read_b32 v246, a55
    v_mul_f32 v246, v246, v245
    v_accvgpr_write_b32 a55, v246
    v_accvgpr_read_b32 v246, a56
    v_mul_f32 v246, v246, v245
    v_accvgpr_write_b32 a56, v246
    v_accvgpr_read_b32 v246, a57
    v_mul_f32 v246, v246, v245
    v_accvgpr_write_b32 a57, v246
    v_accvgpr_read_b32 v246, a58
    v_mul_f32 v246, v246, v245
    v_accvgpr_write_b32 a58, v246
    v_accvgpr_read_b32 v246, a59
    v_mul_f32 v246, v246, v245
    v_accvgpr_write_b32 a59, v246
    v_accvgpr_read_b32 v246, a60
    v_mul_f32 v246, v246, v245
    v_accvgpr_write_b32 a60, v246
    v_accvgpr_read_b32 v246, a61
    v_mul_f32 v246, v246, v245
    v_accvgpr_write_b32 a61, v246
    v_accvgpr_read_b32 v246, a62
    v_mul_f32 v246, v246, v245
    v_accvgpr_write_b32 a62, v246
    v_accvgpr_read_b32 v246, a63
    v_mul_f32 v246, v246, v245
    v_accvgpr_write_b32 a63, v246
    v_sub_f32 v24, v56, v244
    v_sub_f32 v25, v57, v244
    v_sub_f32 v26, v58, v244
    v_sub_f32 v27, v59, v244
    v_sub_f32 v28, v60, v244
    v_sub_f32 v29, v61, v244
    v_sub_f32 v30, v62, v244
    v_sub_f32 v31, v63, v244
    v_exp_f32 v24, v24
    v_exp_f32 v25, v25
    v_exp_f32 v26, v26
    v_exp_f32 v27, v27
    v_exp_f32 v28, v28
    v_exp_f32 v29, v29
    v_exp_f32 v30, v30
    v_exp_f32 v31, v31
    s_nop 0
    v_cvt_pk_bf16_f32 v140, v24, v25
    v_cvt_pk_bf16_f32 v141, v26, v27
    v_cvt_pk_bf16_f32 v142, v28, v29
    v_cvt_pk_bf16_f32 v143, v30, v31
    s_nop 1
    v_mfma_f32_16x16x32_bf16 v[124:127], v[248:251], v[140:143], 0
    s_nop 7
    s_branch L_back1
L_rare2:
    s_nop 7
    v_max3_f32 v244, v64, v65, v66
    v_max3_f32 v244, v244, v67, v68
    v_max3_f32 v244, v244, v69, v70
    v_max_f32 v244, v244, v71
    v_mov_b32 v24, v244
    v_mov_b32 v25, v244
    s_nop 1
    v_permlane16_swap_b32 v24, v25
    s_nop 1
    v_max_f32 v244, v24, v25
    v_mov_b32 v24, v244
    v_mov_b32 v25, v244
    s_nop 1
    v_permlane32_swap_b32 v24, v25
    s_nop 1
    v_max_f32 v244, v24, v25
    v_max_f32 v244, 0, v244
    v_exp_f32 v245, -v244
    v_sub_f32 v96, v96, v244
    v_sub_f32 v97, v97, v244
    v_sub_f32 v98, v98, v244
    v_sub_f32 v99, v99, v244
    v_sub_f32 v32, v32, v244
    v_sub_f32 v33, v33, v244
    v_sub_f32 v34, v34, v244
    v_sub_f32 v35, v35, v244
    v_sub_f32 v36, v36, v244
    v_sub_f32 v37, v37, v244
    v_sub_f32 v38, v38, v244
    v_sub_f32 v39, v39, v244
    v_mul_f32 v20, v20, v245
    v_mul_f32 v160, v160, v245
    v_mul_f32 v161, v161, v245
    v_mul_f32 v162, v162, v245
    v_mul_f32 v163, v163, v245
    v_mul_f32 v164, v164, v245
    v_mul_f32 v165, v165, v245
    v_mul_f32 v166, v166, v245
    v_mul_f32 v167, v167, v245
    v_mul_f32 v168, v168, v245
    v_mul_f32 v169, v169, v245
    v_mul_f32 v170, v170, v245
    v_mul_f32 v171, v171, v245
    v_mul_f32 v172, v172, v245
    v_mul_f32 v173, v173, v245
    v_mul_f32 v174, v174, v245
    v_mul_f32 v175, v175, v245
    v_mul_f32 v176, v176, v245
    v_mul_f32 v177, v177, v245
    v_mul_f32 v178, v178, v245
    v_mul_f32 v179, v179, v245
    v_mul_f32 v180, v180, v245
    v_mul_f32 v181, v181, v245
    v_mul_f32 v182, v182, v245
    v_mul_f32 v183, v183, v245
    v_mul_f32 v184, v184, v245
    v_mul_f32 v185, v185, v245
    v_mul_f32 v186, v186, v245
    v_mul_f32 v187, v187, v245
    v_mul_f32 v188, v188, v245
    v_mul_f32 v189, v189, v245
    v_mul_f32 v190, v190, v245
    v_mul_f32 v191, v191, v245
    v_sub_f32 v24, v64, v244
    v_sub_f32 v25, v65, v244
    v_sub_f32 v26, v66, v244
    v_sub_f32 v27, v67, v244
    v_sub_f32 v28, v68, v244
    v_sub_f32 v29, v69, v244
    v_sub_f32 v30, v70, v244
    v_sub_f32 v31, v71, v244
    v_exp_f32 v24, v24
    v_exp_f32 v25, v25
    v_exp_f32 v26, v26
    v_exp_f32 v27, v27
    v_exp_f32 v28, v28
    v_exp_f32 v29, v29
    v_exp_f32 v30, v30
    v_exp_f32 v31, v31
    s_nop 0
    v_cvt_pk_bf16_f32 v144, v24, v25
    v_cvt_pk_bf16_f32 v145, v26, v27
    v_cvt_pk_bf16_f32 v146, v28, v29
    v_cvt_pk_bf16_f32 v147, v30, v31
    s_nop 1
    v_mfma_f32_16x16x32_bf16 v[112:115], v[248:251], v[144:147], 0
    v_max3_f32 v244, v72, v73, v74
    v_max3_f32 v244, v244, v75, v76
    v_max3_f32 v244, v244, v77, v78
    v_max_f32 v244, v244, v79
    v_mov_b32 v24, v244
    v_mov_b32 v25, v244
    s_nop 1
    v_permlane16_swap_b32 v24, v25
    s_nop 1
    v_max_f32 v244, v24, v25
    v_mov_b32 v24, v244
    v_mov_b32 v25, v244
    s_nop 1
    v_permlane32_swap_b32 v24, v25
    s_nop 1
    v_max_f32 v244, v24, v25
    v_max_f32 v244, 0, v244
    v_exp_f32 v245, -v244
    v_sub_f32 v100, v100, v244
    v_sub_f32 v101, v101, v244
    v_sub_f32 v102, v102, v244
    v_sub_f32 v103, v103, v244
    v_sub_f32 v40, v40, v244
    v_sub_f32 v41, v41, v244
    v_sub_f32 v42, v42, v244
    v_sub_f32 v43, v43, v244
    v_sub_f32 v44, v44, v244
    v_sub_f32 v45, v45, v244
    v_sub_f32 v46, v46, v244
    v_sub_f32 v47, v47, v244
    v_mul_f32 v21, v21, v245
    v_mul_f32 v192, v192, v245
    v_mul_f32 v193, v193, v245
    v_mul_f32 v194, v194, v245
    v_mul_f32 v195, v195, v245
    v_mul_f32 v196, v196, v245
    v_mul_f32 v197, v197, v245
    v_mul_f32 v198, v198, v245
    v_mul_f32 v199, v199, v245
    v_mul_f32 v200, v200, v245
    v_mul_f32 v201, v201, v245
    v_mul_f32 v202, v202, v245
    v_mul_f32 v203, v203, v245
    v_mul_f32 v204, v204, v245
    v_mul_f32 v205, v205, v245
    v_mul_f32 v206, v206, v245
    v_mul_f32 v207, v207, v245
    v_mul_f32 v208, v208, v245
    v_mul_f32 v209, v209, v245
    v_mul_f32 v210, v210, v245
    v_mul_f32 v211, v211, v245
    v_mul_f32 v212, v212, v245
    v_mul_f32 v213, v213, v245
    v_mul_f32 v214, v214, v245
    v_mul_f32 v215, v215, v245
    v_mul_f32 v216, v216, v245
    v_mul_f32 v217, v217, v245
    v_mul_f32 v218, v218, v245
    v_mul_f32 v219, v219, v245
    v_mul_f32 v220, v220, v245
    v_mul_f32 v221, v221, v245
    v_mul_f32 v222, v222, v245
    v_mul_f32 v223, v223, v245
    v_sub_f32 v24, v72, v244
    v_sub_f32 v25, v73, v244
    v_sub_f32 v26, v74, v244
    v_sub_f32 v27, v75, v244
    v_sub_f32 v28, v76, v244
    v_sub_f32 v29, v77, v244
    v_sub_f32 v30, v78, v244
    v_sub_f32 v31, v79, v244
    v_exp_f32 v24, v24
    v_exp_f32 v25, v25
    v_exp_f32 v26, v26
    v_exp_f32 v27, v27
    v_exp_f32 v28, v28
    v_exp_f32 v29, v29
    v_exp_f32 v30, v30
    v_exp_f32 v31, v31
    s_nop 0
    v_cvt_pk_bf16_f32 v148, v24, v25
    v_cvt_pk_bf16_f32 v149, v26, v27
    v_cvt_pk_bf16_f32 v150, v28, v29
    v_cvt_pk_bf16_f32 v151, v30, v31
    s_nop 1
    v_mfma_f32_16x16x32_bf16 v[116:119], v[248:251], v[148:151], 0
    v_max3_f32 v244, v80, v81, v82
    v_max3_f32 v244, v244, v83, v84
    v_max3_f32 v244, v244, v85, v86
    v_max_f32 v244, v244, v87
    v_mov_b32 v24, v244
    v_mov_b32 v25, v244
    s_nop 1
    v_permlane16_swap_b32 v24, v25
    s_nop 1
    v_max_f32 v244, v24, v25
    v_mov_b32 v24, v244
    v_mov_b32 v25, v244
    s_nop 1
    v_permlane32_swap_b32 v24, v25
    s_nop 1
    v_max_f32 v244, v24, v25
    v_max_f32 v244, 0, v244
    v_exp_f32 v245, -v244
    v_sub_f32 v104, v104, v244
    v_sub_f32 v105, v105, v244
    v_sub_f32 v106, v106, v244
    v_sub_f32 v107, v107, v244
    v_sub_f32 v48, v48, v244
    v_sub_f32 v49, v49, v244
    v_sub_f32 v50, v50, v244
    v_sub_f32 v51, v51, v244
    v_sub_f32 v52, v52, v244
    v_sub_f32 v53, v53, v244
    v_sub_f32 v54, v54, v244
    v_sub_f32 v55, v55, v244
    v_mul_f32 v22, v22, v245
    v_accvgpr_read_b32 v246, a0
    v_mul_f32 v246, v246, v245
    v_accvgpr_write_b32 a0, v246
    v_accvgpr_read_b32 v246, a1
    v_mul_f32 v246, v246, v245
    v_accvgpr_write_b32 a1, v246
    v_accvgpr_read_b32 v246, a2
    v_mul_f32 v246, v246, v245
    v_accvgpr_write_b32 a2, v246
    v_accvgpr_read_b32 v246, a3
    v_mul_f32 v246, v246, v245
    v_accvgpr_write_b32 a3, v246
    v_accvgpr_read_b32 v246, a4
    v_mul_f32 v246, v246, v245
    v_accvgpr_write_b32 a4, v246
    v_accvgpr_read_b32 v246, a5
    v_mul_f32 v246, v246, v245
    v_accvgpr_write_b32 a5, v246
    v_accvgpr_read_b32 v246, a6
    v_mul_f32 v246, v246, v245
    v_accvgpr_write_b32 a6, v246
    v_accvgpr_read_b32 v246, a7
    v_mul_f32 v246, v246, v245
    v_accvgpr_write_b32 a7, v246
    v_accvgpr_read_b32 v246, a8
    v_mul_f32 v246, v246, v245
    v_accvgpr_write_b32 a8, v246
    v_accvgpr_read_b32 v246, a9
    v_mul_f32 v246, v246, v245
    v_accvgpr_write_b32 a9, v246
    v_accvgpr_read_b32 v246, a10
    v_mul_f32 v246, v246, v245
    v_accvgpr_write_b32 a10, v246
    v_accvgpr_read_b32 v246, a11
    v_mul_f32 v246, v246, v245
    v_accvgpr_write_b32 a11, v246
    v_accvgpr_read_b32 v246, a12
    v_mul_f32 v246, v246, v245
    v_accvgpr_write_b32 a12, v246
    v_accvgpr_read_b32 v246, a13
    v_mul_f32 v246, v246, v245
    v_accvgpr_write_b32 a13, v246
    v_accvgpr_read_b32 v246, a14
    v_mul_f32 v246, v246, v245
    v_accvgpr_write_b32 a14, v246
    v_accvgpr_read_b32 v246, a15
    v_mul_f32 v246, v246, v245
    v_accvgpr_write_b32 a15, v246
    v_accvgpr_read_b32 v246, a16
    v_mul_f32 v246, v246, v245
    v_accvgpr_write_b32 a16, v246
    v_accvgpr_read_b32 v246, a17
    v_mul_f32 v246, v246, v245
    v_accvgpr_write_b32 a17, v246
    v_accvgpr_read_b32 v246, a18
    v_mul_f32 v246, v246, v245
    v_accvgpr_write_b32 a18, v246
    v_accvgpr_read_b32 v246, a19
    v_mul_f32 v246, v246, v245
    v_accvgpr_write_b32 a19, v246
    v_accvgpr_read_b32 v246, a20
    v_mul_f32 v246, v246, v245
    v_accvgpr_write_b32 a20, v246
    v_accvgpr_read_b32 v246, a21
    v_mul_f32 v246, v246, v245
    v_accvgpr_write_b32 a21, v246
    v_accvgpr_read_b32 v246, a22
    v_mul_f32 v246, v246, v245
    v_accvgpr_write_b32 a22, v246
    v_accvgpr_read_b32 v246, a23
    v_mul_f32 v246, v246, v245
    v_accvgpr_write_b32 a23, v246
    v_accvgpr_read_b32 v246, a24
    v_mul_f32 v246, v246, v245
    v_accvgpr_write_b32 a24, v246
    v_accvgpr_read_b32 v246, a25
    v_mul_f32 v246, v246, v245
    v_accvgpr_write_b32 a25, v246
    v_accvgpr_read_b32 v246, a26
    v_mul_f32 v246, v246, v245
    v_accvgpr_write_b32 a26, v246
    v_accvgpr_read_b32 v246, a27
    v_mul_f32 v246, v246, v245
    v_accvgpr_write_b32 a27, v246
    v_accvgpr_read_b32 v246, a28
    v_mul_f32 v246, v246, v245
    v_accvgpr_write_b32 a28, v246
    v_accvgpr_read_b32 v246, a29
    v_mul_f32 v246, v246, v245
    v_accvgpr_write_b32 a29, v246
    v_accvgpr_read_b32 v246, a30
    v_mul_f32 v246, v246, v245
    v_accvgpr_write_b32 a30, v246
    v_accvgpr_read_b32 v246, a31
    v_mul_f32 v246, v246, v245
    v_accvgpr_write_b32 a31, v246
    v_sub_f32 v24, v80, v244
    v_sub_f32 v25, v81, v244
    v_sub_f32 v26, v82, v244
    v_sub_f32 v27, v83, v244
    v_sub_f32 v28, v84, v244
    v_sub_f32 v29, v85, v244
    v_sub_f32 v30, v86, v244
    v_sub_f32 v31, v87, v244
    v_exp_f32 v24, v24
    v_exp_f32 v25, v25
    v_exp_f32 v26, v26
    v_exp_f32 v27, v27
    v_exp_f32 v28, v28
    v_exp_f32 v29, v29
    v_exp_f32 v30, v30
    v_exp_f32 v31, v31
    s_nop 0
    v_cvt_pk_bf16_f32 v152, v24, v25
    v_cvt_pk_bf16_f32 v153, v26, v27
    v_cvt_pk_bf16_f32 v154, v28, v29
    v_cvt_pk_bf16_f32 v155, v30, v31
    s_nop 1
    v_mfma_f32_16x16x32_bf16 v[120:123], v[248:251], v[152:155], 0
    v_max3_f32 v244, v88, v89, v90
    v_max3_f32 v244, v244, v91, v92
    v_max3_f32 v244, v244, v93, v94
    v_max_f32 v244, v244, v95
    v_mov_b32 v24, v244
    v_mov_b32 v25, v244
    s_nop 1
    v_permlane16_swap_b32 v24, v25
    s_nop 1
    v_max_f32 v244, v24, v25
    v_mov_b32 v24, v244
    v_mov_b32 v25, v244
    s_nop 1
    v_permlane32_swap_b32 v24, v25
    s_nop 1
    v_max_f32 v244, v24, v25
    v_max_f32 v244, 0, v244
    v_exp_f32 v245, -v244
    v_sub_f32 v108, v108, v244
    v_sub_f32 v109, v109, v244
    v_sub_f32 v110, v110, v244
    v_sub_f32 v111, v111, v244
    v_sub_f32 v56, v56, v244
    v_sub_f32 v57, v57, v244
    v_sub_f32 v58, v58, v244
    v_sub_f32 v59, v59, v244
    v_sub_f32 v60, v60, v244
    v_sub_f32 v61, v61, v244
    v_sub_f32 v62, v62, v244
    v_sub_f32 v63, v63, v244
    v_mul_f32 v23, v23, v245
    v_accvgpr_read_b32 v246, a32
    v_mul_f32 v246, v246, v245
    v_accvgpr_write_b32 a32, v246
    v_accvgpr_read_b32 v246, a33
    v_mul_f32 v246, v246, v245
    v_accvgpr_write_b32 a33, v246
    v_accvgpr_read_b32 v246, a34
    v_mul_f32 v246, v246, v245
    v_accvgpr_write_b32 a34, v246
    v_accvgpr_read_b32 v246, a35
    v_mul_f32 v246, v246, v245
    v_accvgpr_write_b32 a35, v246
    v_accvgpr_read_b32 v246, a36
    v_mul_f32 v246, v246, v245
    v_accvgpr_write_b32 a36, v246
    v_accvgpr_read_b32 v246, a37
    v_mul_f32 v246, v246, v245
    v_accvgpr_write_b32 a37, v246
    v_accvgpr_read_b32 v246, a38
    v_mul_f32 v246, v246, v245
    v_accvgpr_write_b32 a38, v246
    v_accvgpr_read_b32 v246, a39
    v_mul_f32 v246, v246, v245
    v_accvgpr_write_b32 a39, v246
    v_accvgpr_read_b32 v246, a40
    v_mul_f32 v246, v246, v245
    v_accvgpr_write_b32 a40, v246
    v_accvgpr_read_b32 v246, a41
    v_mul_f32 v246, v246, v245
    v_accvgpr_write_b32 a41, v246
    v_accvgpr_read_b32 v246, a42
    v_mul_f32 v246, v246, v245
    v_accvgpr_write_b32 a42, v246
    v_accvgpr_read_b32 v246, a43
    v_mul_f32 v246, v246, v245
    v_accvgpr_write_b32 a43, v246
    v_accvgpr_read_b32 v246, a44
    v_mul_f32 v246, v246, v245
    v_accvgpr_write_b32 a44, v246
    v_accvgpr_read_b32 v246, a45
    v_mul_f32 v246, v246, v245
    v_accvgpr_write_b32 a45, v246
    v_accvgpr_read_b32 v246, a46
    v_mul_f32 v246, v246, v245
    v_accvgpr_write_b32 a46, v246
    v_accvgpr_read_b32 v246, a47
    v_mul_f32 v246, v246, v245
    v_accvgpr_write_b32 a47, v246
    v_accvgpr_read_b32 v246, a48
    v_mul_f32 v246, v246, v245
    v_accvgpr_write_b32 a48, v246
    v_accvgpr_read_b32 v246, a49
    v_mul_f32 v246, v246, v245
    v_accvgpr_write_b32 a49, v246
    v_accvgpr_read_b32 v246, a50
    v_mul_f32 v246, v246, v245
    v_accvgpr_write_b32 a50, v246
    v_accvgpr_read_b32 v246, a51
    v_mul_f32 v246, v246, v245
    v_accvgpr_write_b32 a51, v246
    v_accvgpr_read_b32 v246, a52
    v_mul_f32 v246, v246, v245
    v_accvgpr_write_b32 a52, v246
    v_accvgpr_read_b32 v246, a53
    v_mul_f32 v246, v246, v245
    v_accvgpr_write_b32 a53, v246
    v_accvgpr_read_b32 v246, a54
    v_mul_f32 v246, v246, v245
    v_accvgpr_write_b32 a54, v246
    v_accvgpr_read_b32 v246, a55
    v_mul_f32 v246, v246, v245
    v_accvgpr_write_b32 a55, v246
    v_accvgpr_read_b32 v246, a56
    v_mul_f32 v246, v246, v245
    v_accvgpr_write_b32 a56, v246
    v_accvgpr_read_b32 v246, a57
    v_mul_f32 v246, v246, v245
    v_accvgpr_write_b32 a57, v246
    v_accvgpr_read_b32 v246, a58
    v_mul_f32 v246, v246, v245
    v_accvgpr_write_b32 a58, v246
    v_accvgpr_read_b32 v246, a59
    v_mul_f32 v246, v246, v245
    v_accvgpr_write_b32 a59, v246
    v_accvgpr_read_b32 v246, a60
    v_mul_f32 v246, v246, v245
    v_accvgpr_write_b32 a60, v246
    v_accvgpr_read_b32 v246, a61
    v_mul_f32 v246, v246, v245
    v_accvgpr_write_b32 a61, v246
    v_accvgpr_read_b32 v246, a62
    v_mul_f32 v246, v246, v245
    v_accvgpr_write_b32 a62, v246
    v_accvgpr_read_b32 v246, a63
    v_mul_f32 v246, v246, v245
    v_accvgpr_write_b32 a63, v246
    v_sub_f32 v24, v88, v244
    v_sub_f32 v25, v89, v244
    v_sub_f32 v26, v90, v244
    v_sub_f32 v27, v91, v244
    v_sub_f32 v28, v92, v244
    v_sub_f32 v29, v93, v244
    v_sub_f32 v30, v94, v244
    v_sub_f32 v31, v95, v244
    v_exp_f32 v24, v24
    v_exp_f32 v25, v25
    v_exp_f32 v26, v26
    v_exp_f32 v27, v27
    v_exp_f32 v28, v28
    v_exp_f32 v29, v29
    v_exp_f32 v30, v30
    v_exp_f32 v31, v31
    s_nop 0
    v_cvt_pk_bf16_f32 v156, v24, v25
    v_cvt_pk_bf16_f32 v157, v26, v27
    v_cvt_pk_bf16_f32 v158, v28, v29
    v_cvt_pk_bf16_f32 v159, v30, v31
    s_nop 1
    v_mfma_f32_16x16x32_bf16 v[124:127], v[248:251], v[156:159], 0
    s_nop 7
    s_branch L_back2
L_rare3:
    s_nop 7
    v_max3_f32 v244, v32, v33, v34
    v_max3_f32 v244, v244, v35, v36
    v_max3_f32 v244, v244, v37, v38
    v_max_f32 v244, v244, v39
    v_mov_b32 v24, v244
    v_mov_b32 v25, v244
    s_nop 1
    v_permlane16_swap_b32 v24, v25
    s_nop 1
    v_max_f32 v244, v24, v25
    v_mov_b32 v24, v244
    v_mov_b32 v25, v244
    s_nop 1
    v_permlane32_swap_b32 v24, v25
    s_nop 1
    v_max_f32 v244, v24, v25
    v_max_f32 v244, 0, v244
    v_exp_f32 v245, -v244
    v_sub_f32 v96, v96, v244
    v_sub_f32 v97, v97, v244
    v_sub_f32 v98, v98, v244
    v_sub_f32 v99, v99, v244
    v_sub_f32 v64, v64, v244
    v_sub_f32 v65, v65, v244
    v_sub_f32 v66, v66, v244
    v_sub_f32 v67, v67, v244
    v_sub_f32 v68, v68, v244
    v_sub_f32 v69, v69, v244
    v_sub_f32 v70, v70, v244
    v_sub_f32 v71, v71, v244
    v_mul_f32 v20, v20, v245
    v_mul_f32 v160, v160, v245
    v_mul_f32 v161, v161, v245
    v_mul_f32 v162, v162, v245
    v_mul_f32 v163, v163, v245
    v_mul_f32 v164, v164, v245
    v_mul_f32 v165, v165, v245
    v_mul_f32 v166, v166, v245
    v_mul_f32 v167, v167, v245
    v_mul_f32 v168, v168, v245
    v_mul_f32 v169, v169, v245
    v_mul_f32 v170, v170, v245
    v_mul_f32 v171, v171, v245
    v_mul_f32 v172, v172, v245
    v_mul_f32 v173, v173, v245
    v_mul_f32 v174, v174, v245
    v_mul_f32 v175, v175, v245
    v_mul_f32 v176, v176, v245
    v_mul_f32 v177, v177, v245
    v_mul_f32 v178, v178, v245
    v_mul_f32 v179, v179, v245
    v_mul_f32 v180, v180, v245
    v_mul_f32 v181, v181, v245
    v_mul_f32 v182, v182, v245
    v_mul_f32 v183, v183, v245
    v_mul_f32 v184, v184, v245
    v_mul_f32 v185, v185, v245
    v_mul_f32 v186, v186, v245
    v_mul_f32 v187, v187, v245
    v_mul_f32 v188, v188, v245
    v_mul_f32 v189, v189, v245
    v_mul_f32 v190, v190, v245
    v_mul_f32 v191, v191, v245
    v_sub_f32 v24, v32, v244
    v_sub_f32 v25, v33, v244
    v_sub_f32 v26, v34, v244
    v_sub_f32 v27, v35, v244
    v_sub_f32 v28, v36, v244
    v_sub_f32 v29, v37, v244
    v_sub_f32 v30, v38, v244
    v_sub_f32 v31, v39, v244
    v_exp_f32 v24, v24
    v_exp_f32 v25, v25
    v_exp_f32 v26, v26
    v_exp_f32 v27, v27
    v_exp_f32 v28, v28
    v_exp_f32 v29, v29
    v_exp_f32 v30, v30
    v_exp_f32 v31, v31
    s_nop 0
    v_cvt_pk_bf16_f32 v128, v24, v25
    v_cvt_pk_bf16_f32 v129, v26, v27
    v_cvt_pk_bf16_f32 v130, v28, v29
    v_cvt_pk_bf16_f32 v131, v30, v31
    s_nop 1
    v_mfma_f32_16x16x32_bf16 v[112:115], v[248:251], v[128:131], 0
    v_max3_f32 v244, v40, v41, v42
    v_max3_f32 v244, v244, v43, v44
    v_max3_f32 v244, v244, v45, v46
    v_max_f32 v244, v244, v47
    v_mov_b32 v24, v244
    v_mov_b32 v25, v244
    s_nop 1
    v_permlane16_swap_b32 v24, v25
    s_nop 1
    v_max_f32 v244, v24, v25
    v_mov_b32 v24, v244
    v_mov_b32 v25, v244
    s_nop 1
    v_permlane32_swap_b32 v24, v25
    s_nop 1
    v_max_f32 v244, v24, v25
    v_max_f32 v244, 0, v244
    v_exp_f32 v245, -v244
    v_sub_f32 v100, v100, v244
    v_sub_f32 v101, v101, v244
    v_sub_f32 v102, v102, v244
    v_sub_f32 v103, v103, v244
    v_sub_f32 v72, v72, v244
    v_sub_f32 v73, v73, v244
    v_sub_f32 v74, v74, v244
    v_sub_f32 v75, v75, v244
    v_sub_f32 v76, v76, v244
    v_sub_f32 v77, v77, v244
    v_sub_f32 v78, v78, v244
    v_sub_f32 v79, v79, v244
    v_mul_f32 v21, v21, v245
    v_mul_f32 v192, v192, v245
    v_mul_f32 v193, v193, v245
    v_mul_f32 v194, v194, v245
    v_mul_f32 v195, v195, v245
    v_mul_f32 v196, v196, v245
    v_mul_f32 v197, v197, v245
    v_mul_f32 v198, v198, v245
    v_mul_f32 v199, v199, v245
    v_mul_f32 v200, v200, v245
    v_mul_f32 v201, v201, v245
    v_mul_f32 v202, v202, v245
    v_mul_f32 v203, v203, v245
    v_mul_f32 v204, v204, v245
    v_mul_f32 v205, v205, v245
    v_mul_f32 v206, v206, v245
    v_mul_f32 v207, v207, v245
    v_mul_f32 v208, v208, v245
    v_mul_f32 v209, v209, v245
    v_mul_f32 v210, v210, v245
    v_mul_f32 v211, v211, v245
    v_mul_f32 v212, v212, v245
    v_mul_f32 v213, v213, v245
    v_mul_f32 v214, v214, v245
    v_mul_f32 v215, v215, v245
    v_mul_f32 v216, v216, v245
    v_mul_f32 v217, v217, v245
    v_mul_f32 v218, v218, v245
    v_mul_f32 v219, v219, v245
    v_mul_f32 v220, v220, v245
    v_mul_f32 v221, v221, v245
    v_mul_f32 v222, v222, v245
    v_mul_f32 v223, v223, v245
    v_sub_f32 v24, v40, v244
    v_sub_f32 v25, v41, v244
    v_sub_f32 v26, v42, v244
    v_sub_f32 v27, v43, v244
    v_sub_f32 v28, v44, v244
    v_sub_f32 v29, v45, v244
    v_sub_f32 v30, v46, v244
    v_sub_f32 v31, v47, v244
    v_exp_f32 v24, v24
    v_exp_f32 v25, v25
    v_exp_f32 v26, v26
    v_exp_f32 v27, v27
    v_exp_f32 v28, v28
    v_exp_f32 v29, v29
    v_exp_f32 v30, v30
    v_exp_f32 v31, v31
    s_nop 0
    v_cvt_pk_bf16_f32 v132, v24, v25
    v_cvt_pk_bf16_f32 v133, v26, v27
    v_cvt_pk_bf16_f32 v134, v28, v29
    v_cvt_pk_bf16_f32 v135, v30, v31
    s_nop 1
    v_mfma_f32_16x16x32_bf16 v[116:119], v[248:251], v[132:135], 0
    v_max3_f32 v244, v48, v49, v50
    v_max3_f32 v244, v244, v51, v52
    v_max3_f32 v244, v244, v53, v54
    v_max_f32 v244, v244, v55
    v_mov_b32 v24, v244
    v_mov_b32 v25, v244
    s_nop 1
    v_permlane16_swap_b32 v24, v25
    s_nop 1
    v_max_f32 v244, v24, v25
    v_mov_b32 v24, v244
    v_mov_b32 v25, v244
    s_nop 1
    v_permlane32_swap_b32 v24, v25
    s_nop 1
    v_max_f32 v244, v24, v25
    v_max_f32 v244, 0, v244
    v_exp_f32 v245, -v244
    v_sub_f32 v104, v104, v244
    v_sub_f32 v105, v105, v244
    v_sub_f32 v106, v106, v244
    v_sub_f32 v107, v107, v244
    v_sub_f32 v80, v80, v244
    v_sub_f32 v81, v81, v244
    v_sub_f32 v82, v82, v244
    v_sub_f32 v83, v83, v244
    v_sub_f32 v84, v84, v244
    v_sub_f32 v85, v85, v244
    v_sub_f32 v86, v86, v244
    v_sub_f32 v87, v87, v244
    v_mul_f32 v22, v22, v245
    v_accvgpr_read_b32 v246, a0
    v_mul_f32 v246, v246, v245
    v_accvgpr_write_b32 a0, v246
    v_accvgpr_read_b32 v246, a1
    v_mul_f32 v246, v246, v245
    v_accvgpr_write_b32 a1, v246
    v_accvgpr_read_b32 v246, a2
    v_mul_f32 v246, v246, v245
    v_accvgpr_write_b32 a2, v246
    v_accvgpr_read_b32 v246, a3
    v_mul_f32 v246, v246, v245
    v_accvgpr_write_b32 a3, v246
    v_accvgpr_read_b32 v246, a4
    v_mul_f32 v246, v246, v245
    v_accvgpr_write_b32 a4, v246
    v_accvgpr_read_b32 v246, a5
    v_mul_f32 v246, v246, v245
    v_accvgpr_write_b32 a5, v246
    v_accvgpr_read_b32 v246, a6
    v_mul_f32 v246, v246, v245
    v_accvgpr_write_b32 a6, v246
    v_accvgpr_read_b32 v246, a7
    v_mul_f32 v246, v246, v245
    v_accvgpr_write_b32 a7, v246
    v_accvgpr_read_b32 v246, a8
    v_mul_f32 v246, v246, v245
    v_accvgpr_write_b32 a8, v246
    v_accvgpr_read_b32 v246, a9
    v_mul_f32 v246, v246, v245
    v_accvgpr_write_b32 a9, v246
    v_accvgpr_read_b32 v246, a10
    v_mul_f32 v246, v246, v245
    v_accvgpr_write_b32 a10, v246
    v_accvgpr_read_b32 v246, a11
    v_mul_f32 v246, v246, v245
    v_accvgpr_write_b32 a11, v246
    v_accvgpr_read_b32 v246, a12
    v_mul_f32 v246, v246, v245
    v_accvgpr_write_b32 a12, v246
    v_accvgpr_read_b32 v246, a13
    v_mul_f32 v246, v246, v245
    v_accvgpr_write_b32 a13, v246
    v_accvgpr_read_b32 v246, a14
    v_mul_f32 v246, v246, v245
    v_accvgpr_write_b32 a14, v246
    v_accvgpr_read_b32 v246, a15
    v_mul_f32 v246, v246, v245
    v_accvgpr_write_b32 a15, v246
    v_accvgpr_read_b32 v246, a16
    v_mul_f32 v246, v246, v245
    v_accvgpr_write_b32 a16, v246
    v_accvgpr_read_b32 v246, a17
    v_mul_f32 v246, v246, v245
    v_accvgpr_write_b32 a17, v246
    v_accvgpr_read_b32 v246, a18
    v_mul_f32 v246, v246, v245
    v_accvgpr_write_b32 a18, v246
    v_accvgpr_read_b32 v246, a19
    v_mul_f32 v246, v246, v245
    v_accvgpr_write_b32 a19, v246
    v_accvgpr_read_b32 v246, a20
    v_mul_f32 v246, v246, v245
    v_accvgpr_write_b32 a20, v246
    v_accvgpr_read_b32 v246, a21
    v_mul_f32 v246, v246, v245
    v_accvgpr_write_b32 a21, v246
    v_accvgpr_read_b32 v246, a22
    v_mul_f32 v246, v246, v245
    v_accvgpr_write_b32 a22, v246
    v_accvgpr_read_b32 v246, a23
    v_mul_f32 v246, v246, v245
    v_accvgpr_write_b32 a23, v246
    v_accvgpr_read_b32 v246, a24
    v_mul_f32 v246, v246, v245
    v_accvgpr_write_b32 a24, v246
    v_accvgpr_read_b32 v246, a25
    v_mul_f32 v246, v246, v245
    v_accvgpr_write_b32 a25, v246
    v_accvgpr_read_b32 v246, a26
    v_mul_f32 v246, v246, v245
    v_accvgpr_write_b32 a26, v246
    v_accvgpr_read_b32 v246, a27
    v_mul_f32 v246, v246, v245
    v_accvgpr_write_b32 a27, v246
    v_accvgpr_read_b32 v246, a28
    v_mul_f32 v246, v246, v245
    v_accvgpr_write_b32 a28, v246
    v_accvgpr_read_b32 v246, a29
    v_mul_f32 v246, v246, v245
    v_accvgpr_write_b32 a29, v246
    v_accvgpr_read_b32 v246, a30
    v_mul_f32 v246, v246, v245
    v_accvgpr_write_b32 a30, v246
    v_accvgpr_read_b32 v246, a31
    v_mul_f32 v246, v246, v245
    v_accvgpr_write_b32 a31, v246
    v_sub_f32 v24, v48, v244
    v_sub_f32 v25, v49, v244
    v_sub_f32 v26, v50, v244
    v_sub_f32 v27, v51, v244
    v_sub_f32 v28, v52, v244
    v_sub_f32 v29, v53, v244
    v_sub_f32 v30, v54, v244
    v_sub_f32 v31, v55, v244
    v_exp_f32 v24, v24
    v_exp_f32 v25, v25
    v_exp_f32 v26, v26
    v_exp_f32 v27, v27
    v_exp_f32 v28, v28
    v_exp_f32 v29, v29
    v_exp_f32 v30, v30
    v_exp_f32 v31, v31
    s_nop 0
    v_cvt_pk_bf16_f32 v136, v24, v25
    v_cvt_pk_bf16_f32 v137, v26, v27
    v_cvt_pk_bf16_f32 v138, v28, v29
    v_cvt_pk_bf16_f32 v139, v30, v31
    s_nop 1
    v_mfma_f32_16x16x32_bf16 v[120:123], v[248:251], v[136:139], 0
    v_max3_f32 v244, v56, v57, v58
    v_max3_f32 v244, v244, v59, v60
    v_max3_f32 v244, v244, v61, v62
    v_max_f32 v244, v244, v63
    v_mov_b32 v24, v244
    v_mov_b32 v25, v244
    s_nop 1
    v_permlane16_swap_b32 v24, v25
    s_nop 1
    v_max_f32 v244, v24, v25
    v_mov_b32 v24, v244
    v_mov_b32 v25, v244
    s_nop 1
    v_permlane32_swap_b32 v24, v25
    s_nop 1
    v_max_f32 v244, v24, v25
    v_max_f32 v244, 0, v244
    v_exp_f32 v245, -v244
    v_sub_f32 v108, v108, v244
    v_sub_f32 v109, v109, v244
    v_sub_f32 v110, v110, v244
    v_sub_f32 v111, v111, v244
    v_sub_f32 v88, v88, v244
    v_sub_f32 v89, v89, v244
    v_sub_f32 v90, v90, v244
    v_sub_f32 v91, v91, v244
    v_sub_f32 v92, v92, v244
    v_sub_f32 v93, v93, v244
    v_sub_f32 v94, v94, v244
    v_sub_f32 v95, v95, v244
    v_mul_f32 v23, v23, v245
    v_accvgpr_read_b32 v246, a32
    v_mul_f32 v246, v246, v245
    v_accvgpr_write_b32 a32, v246
    v_accvgpr_read_b32 v246, a33
    v_mul_f32 v246, v246, v245
    v_accvgpr_write_b32 a33, v246
    v_accvgpr_read_b32 v246, a34
    v_mul_f32 v246, v246, v245
    v_accvgpr_write_b32 a34, v246
    v_accvgpr_read_b32 v246, a35
    v_mul_f32 v246, v246, v245
    v_accvgpr_write_b32 a35, v246
    v_accvgpr_read_b32 v246, a36
    v_mul_f32 v246, v246, v245
    v_accvgpr_write_b32 a36, v246
    v_accvgpr_read_b32 v246, a37
    v_mul_f32 v246, v246, v245
    v_accvgpr_write_b32 a37, v246
    v_accvgpr_read_b32 v246, a38
    v_mul_f32 v246, v246, v245
    v_accvgpr_write_b32 a38, v246
    v_accvgpr_read_b32 v246, a39
    v_mul_f32 v246, v246, v245
    v_accvgpr_write_b32 a39, v246
    v_accvgpr_read_b32 v246, a40
    v_mul_f32 v246, v246, v245
    v_accvgpr_write_b32 a40, v246
    v_accvgpr_read_b32 v246, a41
    v_mul_f32 v246, v246, v245
    v_accvgpr_write_b32 a41, v246
    v_accvgpr_read_b32 v246, a42
    v_mul_f32 v246, v246, v245
    v_accvgpr_write_b32 a42, v246
    v_accvgpr_read_b32 v246, a43
    v_mul_f32 v246, v246, v245
    v_accvgpr_write_b32 a43, v246
    v_accvgpr_read_b32 v246, a44
    v_mul_f32 v246, v246, v245
    v_accvgpr_write_b32 a44, v246
    v_accvgpr_read_b32 v246, a45
    v_mul_f32 v246, v246, v245
    v_accvgpr_write_b32 a45, v246
    v_accvgpr_read_b32 v246, a46
    v_mul_f32 v246, v246, v245
    v_accvgpr_write_b32 a46, v246
    v_accvgpr_read_b32 v246, a47
    v_mul_f32 v246, v246, v245
    v_accvgpr_write_b32 a47, v246
    v_accvgpr_read_b32 v246, a48
    v_mul_f32 v246, v246, v245
    v_accvgpr_write_b32 a48, v246
    v_accvgpr_read_b32 v246, a49
    v_mul_f32 v246, v246, v245
    v_accvgpr_write_b32 a49, v246
    v_accvgpr_read_b32 v246, a50
    v_mul_f32 v246, v246, v245
    v_accvgpr_write_b32 a50, v246
    v_accvgpr_read_b32 v246, a51
    v_mul_f32 v246, v246, v245
    v_accvgpr_write_b32 a51, v246
    v_accvgpr_read_b32 v246, a52
    v_mul_f32 v246, v246, v245
    v_accvgpr_write_b32 a52, v246
    v_accvgpr_read_b32 v246, a53
    v_mul_f32 v246, v246, v245
    v_accvgpr_write_b32 a53, v246
    v_accvgpr_read_b32 v246, a54
    v_mul_f32 v246, v246, v245
    v_accvgpr_write_b32 a54, v246
    v_accvgpr_read_b32 v246, a55
    v_mul_f32 v246, v246, v245
    v_accvgpr_write_b32 a55, v246
    v_accvgpr_read_b32 v246, a56
    v_mul_f32 v246, v246, v245
    v_accvgpr_write_b32 a56, v246
    v_accvgpr_read_b32 v246, a57
    v_mul_f32 v246, v246, v245
    v_accvgpr_write_b32 a57, v246
    v_accvgpr_read_b32 v246, a58
    v_mul_f32 v246, v246, v245
    v_accvgpr_write_b32 a58, v246
    v_accvgpr_read_b32 v246, a59
    v_mul_f32 v246, v246, v245
    v_accvgpr_write_b32 a59, v246
    v_accvgpr_read_b32 v246, a60
    v_mul_f32 v246, v246, v245
    v_accvgpr_write_b32 a60, v246
    v_accvgpr_read_b32 v246, a61
    v_mul_f32 v246, v246, v245
    v_accvgpr_write_b32 a61, v246
    v_accvgpr_read_b32 v246, a62
    v_mul_f32 v246, v246, v245
    v_accvgpr_write_b32 a62, v246
    v_accvgpr_read_b32 v246, a63
    v_mul_f32 v246, v246, v245
    v_accvgpr_write_b32 a63, v246
    v_sub_f32 v24, v56, v244
    v_sub_f32 v25, v57, v244
    v_sub_f32 v26, v58, v244
    v_sub_f32 v27, v59, v244
    v_sub_f32 v28, v60, v244
    v_sub_f32 v29, v61, v244
    v_sub_f32 v30, v62, v244
    v_sub_f32 v31, v63, v244
    v_exp_f32 v24, v24
    v_exp_f32 v25, v25
    v_exp_f32 v26, v26
    v_exp_f32 v27, v27
    v_exp_f32 v28, v28
    v_exp_f32 v29, v29
    v_exp_f32 v30, v30
    v_exp_f32 v31, v31
    s_nop 0
    v_cvt_pk_bf16_f32 v140, v24, v25
    v_cvt_pk_bf16_f32 v141, v26, v27
    v_cvt_pk_bf16_f32 v142, v28, v29
    v_cvt_pk_bf16_f32 v143, v30, v31
    s_nop 1
    v_mfma_f32_16x16x32_bf16 v[124:127], v[248:251], v[140:143], 0
    s_nop 7
    s_branch L_back3
L_rareT:
    s_nop 7
    v_max3_f32 v244, v32, v33, v34
    v_max3_f32 v244, v244, v35, v36
    v_max3_f32 v244, v244, v37, v38
    v_max_f32 v244, v244, v39
    v_mov_b32 v24, v244
    v_mov_b32 v25, v244
    s_nop 1
    v_permlane16_swap_b32 v24, v25
    s_nop 1
    v_max_f32 v244, v24, v25
    v_mov_b32 v24, v244
    v_mov_b32 v25, v244
    s_nop 1
    v_permlane32_swap_b32 v24, v25
    s_nop 1
    v_max_f32 v244, v24, v25
    v_max_f32 v244, 0, v244
    v_exp_f32 v245, -v244
    v_sub_f32 v96, v96, v244
    v_sub_f32 v97, v97, v244
    v_sub_f32 v98, v98, v244
    v_sub_f32 v99, v99, v244
    v_mul_f32 v20, v20, v245
    v_mul_f32 v160, v160, v245
    v_mul_f32 v161, v161, v245
    v_mul_f32 v162, v162, v245
    v_mul_f32 v163, v163, v245
    v_mul_f32 v164, v164, v245
    v_mul_f32 v165, v165, v245
    v_mul_f32 v166, v166, v245
    v_mul_f32 v167, v167, v245
    v_mul_f32 v168, v168, v245
    v_mul_f32 v169, v169, v245
    v_mul_f32 v170, v170, v245
    v_mul_f32 v171, v171, v245
    v_mul_f32 v172, v172, v245
    v_mul_f32 v173, v173, v245
    v_mul_f32 v174, v174, v245
    v_mul_f32 v175, v175, v245
    v_mul_f32 v176, v176, v245
    v_mul_f32 v177, v177, v245
    v_mul_f32 v178, v178, v245
    v_mul_f32 v179, v179, v245
    v_mul_f32 v180, v180, v245
    v_mul_f32 v181, v181, v245
    v_mul_f32 v182, v182, v245
    v_mul_f32 v183, v183, v245
    v_mul_f32 v184, v184, v245
    v_mul_f32 v185, v185, v245
    v_mul_f32 v186, v186, v245
    v_mul_f32 v187, v187, v245
    v_mul_f32 v188, v188, v245
    v_mul_f32 v189, v189, v245
    v_mul_f32 v190, v190, v245
    v_mul_f32 v191, v191, v245
    v_sub_f32 v24, v32, v244
    v_sub_f32 v25, v33, v244
    v_sub_f32 v26, v34, v244
    v_sub_f32 v27, v35, v244
    v_sub_f32 v28, v36, v244
    v_sub_f32 v29, v37, v244
    v_sub_f32 v30, v38, v244
    v_sub_f32 v31, v39, v244
    v_exp_f32 v24, v24
    v_exp_f32 v25, v25
    v_exp_f32 v26, v26
    v_exp_f32 v27, v27
    v_exp_f32 v28, v28
    v_exp_f32 v29, v29
    v_exp_f32 v30, v30
    v_exp_f32 v31, v31
    s_nop 0
    v_cvt_pk_bf16_f32 v128, v24, v25
    v_cvt_pk_bf16_f32 v129, v26, v27
    v_cvt_pk_bf16_f32 v130, v28, v29
    v_cvt_pk_bf16_f32 v131, v30, v31
    s_nop 1
    v_mfma_f32_16x16x32_bf16 v[112:115], v[248:251], v[128:131], 0
    v_max3_f32 v244, v40, v41, v42
    v_max3_f32 v244, v244, v43, v44
    v_max3_f32 v244, v244, v45, v46
    v_max_f32 v244, v244, v47
    v_mov_b32 v24, v244
    v_mov_b32 v25, v244
    s_nop 1
    v_permlane16_swap_b32 v24, v25
    s_nop 1
    v_max_f32 v244, v24, v25
    v_mov_b32 v24, v244
    v_mov_b32 v25, v244
    s_nop 1
    v_permlane32_swap_b32 v24, v25
    s_nop 1
    v_max_f32 v244, v24, v25
    v_max_f32 v244, 0, v244
    v_exp_f32 v245, -v244
    v_sub_f32 v100, v100, v244
    v_sub_f32 v101, v101, v244
    v_sub_f32 v102, v102, v244
    v_sub_f32 v103, v103, v244
    v_mul_f32 v21, v21, v245
    v_mul_f32 v192, v192, v245
    v_mul_f32 v193, v193, v245
    v_mul_f32 v194, v194, v245
    v_mul_f32 v195, v195, v245
    v_mul_f32 v196, v196, v245
    v_mul_f32 v197, v197, v245
    v_mul_f32 v198, v198, v245
    v_mul_f32 v199, v199, v245
    v_mul_f32 v200, v200, v245
    v_mul_f32 v201, v201, v245
    v_mul_f32 v202, v202, v245
    v_mul_f32 v203, v203, v245
    v_mul_f32 v204, v204, v245
    v_mul_f32 v205, v205, v245
    v_mul_f32 v206, v206, v245
    v_mul_f32 v207, v207, v245
    v_mul_f32 v208, v208, v245
    v_mul_f32 v209, v209, v245
    v_mul_f32 v210, v210, v245
    v_mul_f32 v211, v211, v245
    v_mul_f32 v212, v212, v245
    v_mul_f32 v213, v213, v245
    v_mul_f32 v214, v214, v245
    v_mul_f32 v215, v215, v245
    v_mul_f32 v216, v216, v245
    v_mul_f32 v217, v217, v245
    v_mul_f32 v218, v218, v245
    v_mul_f32 v219, v219, v245
    v_mul_f32 v220, v220, v245
    v_mul_f32 v221, v221, v245
    v_mul_f32 v222, v222, v245
    v_mul_f32 v223, v223, v245
    v_sub_f32 v24, v40, v244
    v_sub_f32 v25, v41, v244
    v_sub_f32 v26, v42, v244
    v_sub_f32 v27, v43, v244
    v_sub_f32 v28, v44, v244
    v_sub_f32 v29, v45, v244
    v_sub_f32 v30, v46, v244
    v_sub_f32 v31, v47, v244
    v_exp_f32 v24, v24
    v_exp_f32 v25, v25
    v_exp_f32 v26, v26
    v_exp_f32 v27, v27
    v_exp_f32 v28, v28
    v_exp_f32 v29, v29
    v_exp_f32 v30, v30
    v_exp_f32 v31, v31
    s_nop 0
    v_cvt_pk_bf16_f32 v132, v24, v25
    v_cvt_pk_bf16_f32 v133, v26, v27
    v_cvt_pk_bf16_f32 v134, v28, v29
    v_cvt_pk_bf16_f32 v135, v30, v31
    s_nop 1
    v_mfma_f32_16x16x32_bf16 v[116:119], v[248:251], v[132:135], 0
    s_nop 7
    s_branch L_backT
.section .rodata,"a"
.p2align 6
.amdhsa_kernel standalone__tree_speculative_verify_tree_attention_over_candidate_token_tree__sampling_kernel
  .amdhsa_next_free_vgpr 512
  .amdhsa_next_free_sgpr 96
  .amdhsa_accum_offset 256
  .amdhsa_group_segment_fixed_size 0
  .amdhsa_kernarg_size 72
  .amdhsa_user_sgpr_count 2
  .amdhsa_user_sgpr_kernarg_segment_ptr 1
  .amdhsa_system_sgpr_workgroup_id_x 1
.end_amdhsa_kernel
```
